```python
import torch

def _softmax(x, axis=-1):
    return torch.softmax(x, dim=axis)
def _gelu(x):
    return torch.nn.functional.gelu(x, approximate="tanh")
def _silu(x):
    return torch.nn.functional.silu(x)
def _sigmoid(x):
    return torch.sigmoid(x)
def _layernorm(x, axis=-1, eps=1e-5):
    m = x.mean(dim=axis, keepdim=True)
    v = x.var(dim=axis, keepdim=True, unbiased=False)
    return (x - m) / torch.sqrt(v + eps)
def _scatter_add(tgt, idx, src, axis=0):
    return tgt.clone().index_add_(axis, idx, src)
def _segment_sum(src, seg, n):
    out = torch.zeros((n,) + src.shape[1:], dtype=src.dtype)
    return out.index_add_(0, seg, src)
def _pad(x, pw):
    flat = tuple(v for pair in reversed(pw) for v in pair)
    return torch.nn.functional.pad(x, flat)

kernel_name = 'parallel_sum__softmax_full_mha__dense_activation_squared_relu__prompt'

def setup_inputs():

    _w = (lambda a: (lambda t: t.to(torch.bfloat16) if t.is_floating_point() else t)(torch.as_tensor(a)))
    def _A_setup():
        B, S, D = 1, 2048, 512
        return {
            "x": _w((lambda *s: torch.randn(*s, dtype=torch.bfloat16) * 0.05)(B, S, D)),
            "wqkv": _w((lambda *s: torch.randn(*s, dtype=torch.bfloat16) * 0.2)(D, 3 * D)),
            "wo": _w((lambda *s: torch.randn(*s, dtype=torch.bfloat16) * 0.1)(D, D)),
        }
    _A_in = _A_setup()

    def _B_setup():
        B, S, D, F = 1, 2048, 512, 1792
        return {
            "x": _w((lambda *s: torch.randn(*s, dtype=torch.bfloat16) * 0.05)(B, S, D)),
            "w1": _w((lambda *s: torch.randn(*s, dtype=torch.bfloat16) * 0.1)(D, F)),
            "b1": _w((lambda *s: torch.randn(*s, dtype=torch.bfloat16) * 0.8)(F)),
            "w2": _w((lambda *s: torch.randn(*s, dtype=torch.bfloat16) * 0.1)(F, D)),
            "b2": _w((lambda *s: torch.randn(*s, dtype=torch.bfloat16) * 12.8)(D)),
        }
    _B_in = _B_setup()

    return {
        "A_x": _A_in["x"],
        "A_wqkv": _A_in["wqkv"],
        "A_wo": _A_in["wo"],
        "B_x": _B_in["x"],
        "B_w1": _B_in["w1"],
        "B_b1": _B_in["b1"],
        "B_w2": _B_in["w2"],
        "B_b2": _B_in["b2"],
    }

def reference(A_x, A_wqkv, A_wo, B_x, B_w1, B_b1, B_w2, B_b2):
    def _A_ref(x, wqkv, wo):
        B, S, D = x.shape
        H = 32; Dh = D // H
        qkv = (lambda x, *d: x.permute(*d))((x @ wqkv).reshape(B, S, 3, H, Dh), 2, 0, 3, 1, 4)
        q, k, v = qkv[0], qkv[1], qkv[2]
        scale = Dh ** -0.5
        scores = torch.einsum("bhqd,bhkd->bhqk", q, k) * scale
        p = _softmax(scores, axis=-1)
        o = torch.einsum("bhqk,bhkd->bhqd", p, v)
        return (lambda x, *d: x.permute(*d))(o, 0, 2, 1, 3).reshape(B, S, D) @ wo

    def _B_ref(x, w1, b1, w2, b2):
        h = torch.einsum("bsd,df->bsf", x, w1) + b1
        zero = torch.zeros_like(h)
        r = torch.where(h > zero, h, zero)
        h = r * r
        out = torch.einsum("bsf,fd->bsd", h, w2) + b2
        return out

    x = A_x
    xn = _layernorm(x, axis=-1)
    return x + _A_ref(xn, A_wqkv, A_wo) + _B_ref(xn, B_w1, B_b1, B_w2, B_b2)
```

```asm
; @launch kernel=kb_kernel grid=(256,1,1) block=(512,1,1) lds=150528
; @launch kernel=k2_kernel grid=(512,1,1) block=(512,1,1) lds=74752
.amdgcn_target "amdgcn-amd-amdhsa--gfx950"
.text
.globl kb_kernel
.p2align 8
.type kb_kernel,@function
kb_kernel:
  s_cmp_ge_u32 s2, 256
  s_cbranch_scc1 L_kb_exit
  s_load_dwordx2 s[4:5], s[0:1], 0
  s_load_dwordx2 s[6:7], s[0:1], 8
  s_load_dwordx2 s[40:41], s[0:1], 32
  s_load_dwordx2 s[8:9], s[0:1], 80
  s_load_dwordx2 s[10:11], s[0:1], 40
  v_lshrrev_b32 v1, 6, v0
  v_and_b32 v0, 63, v0
  v_readfirstlane_b32 s24, v1
  s_getpc_b64 s[50:51]
L_kb_pc:
  s_sub_u32 s50, s50, L_kb_pc-kb_kernel
  s_subb_u32 s51, s51, 0
  s_lshr_b32 s52, s2, 3
  s_lshl_b32 s52, s52, 10
  v_lshl_add_u32 v3, v0, 4, s52
  v_cmp_gt_u32 vcc, L_text_end-kb_kernel-16, v3
  s_cmp_eq_u32 s24, 7
  s_cselect_b64 s[52:53], vcc, 0
  s_and_saveexec_b64 s[54:55], s[52:53]
  s_cbranch_execz L_kb_npf
  global_load_dwordx4 v[112:115], v3, s[50:51]
L_kb_npf:
  s_mov_b64 exec, s[54:55]
  s_lshr_b32 s27, s2, 3
  s_and_b32 s37, s27, 7
  s_and_b32 s25, s2, 3
  s_lshl_b32 s25, s25, 3
  s_add_u32 s25, s25, s37
  s_lshr_b32 s27, s27, 3
  s_bfe_u32 s26, s2, 0x10002
  s_lshl_b32 s26, s26, 2
  s_add_u32 s26, s26, s27
  s_lshl_b32 s37, s37, 1
  s_lshl_b32 s27, s27, 1
  s_add_u32 s27, s27, s24
  s_and_b32 s27, s27, 7
  s_lshl_b32 s36, s27, 3
  v_lshlrev_b32 v3, 4, v0
  s_lshl_b32 s27, s25, 6
  s_add_u32 s27, s27, s36
  s_lshl_b32 s28, s27, 10
  s_lshl_b32 m0, s36, 10
  s_and_b32 s36, s36, 8
  s_waitcnt lgkmcnt(0)
  s_mov_b32 s12, s4
  s_and_b32 s13, s5, 0xffff
  s_mov_b32 s14, 0x200000
  s_mov_b32 s15, 0x20000
  s_add_u32 s27, s36, 0
  s_lshl_b32 s27, s27, 4
  v_xor_b32 v4, s27, v3
  buffer_load_dwordx4 v4, s[12:15], s28 offen lds
  s_add_u32 m0, m0, 1024
  s_add_u32 s28, s28, 1024
  s_add_u32 s27, s36, 1
  s_lshl_b32 s27, s27, 4
  v_xor_b32 v4, s27, v3
  buffer_load_dwordx4 v4, s[12:15], s28 offen lds
  s_add_u32 m0, m0, 1024
  s_add_u32 s28, s28, 1024
  s_add_u32 s27, s36, 2
  s_lshl_b32 s27, s27, 4
  v_xor_b32 v4, s27, v3
  buffer_load_dwordx4 v4, s[12:15], s28 offen lds
  s_add_u32 m0, m0, 1024
  s_add_u32 s28, s28, 1024
  s_add_u32 s27, s36, 3
  s_lshl_b32 s27, s27, 4
  v_xor_b32 v4, s27, v3
  buffer_load_dwordx4 v4, s[12:15], s28 offen lds
  s_add_u32 m0, m0, 1024
  s_add_u32 s28, s28, 1024
  s_add_u32 s27, s36, 4
  s_lshl_b32 s27, s27, 4
  v_xor_b32 v4, s27, v3
  buffer_load_dwordx4 v4, s[12:15], s28 offen lds
  s_add_u32 m0, m0, 1024
  s_add_u32 s28, s28, 1024
  s_add_u32 s27, s36, 5
  s_lshl_b32 s27, s27, 4
  v_xor_b32 v4, s27, v3
  buffer_load_dwordx4 v4, s[12:15], s28 offen lds
  s_add_u32 m0, m0, 1024
  s_add_u32 s28, s28, 1024
  s_add_u32 s27, s36, 6
  s_lshl_b32 s27, s27, 4
  v_xor_b32 v4, s27, v3
  buffer_load_dwordx4 v4, s[12:15], s28 offen lds
  s_add_u32 m0, m0, 1024
  s_add_u32 s28, s28, 1024
  s_add_u32 s27, s36, 7
  s_lshl_b32 s27, s27, 4
  v_xor_b32 v4, s27, v3
  buffer_load_dwordx4 v4, s[12:15], s28 offen lds
  v_and_b32 v1, 31, v0
  v_lshrrev_b32 v2, 5, v0
  s_mov_b32 s20, s8
  s_and_b32 s21, s9, 0xffff
  s_mov_b32 s22, 0x1600000
  s_mov_b32 s23, 0x20000
  s_mov_b32 s16, s6
  s_and_b32 s17, s7, 0xffff
  s_mov_b32 s18, 0x180000
  s_mov_b32 s19, 0x20000
  v_mov_b32 v6, 0
  v_mov_b32 v7, 0
  v_mov_b32 v8, 0
  v_mov_b32 v9, 0
  v_mov_b32 v10, 0
  s_cmp_lt_u32 s2, 48
  s_cbranch_scc0 L_kb_nz
  s_cmp_eq_u32 s24, 0
  s_cbranch_scc0 L_kb_nz
  s_lshl_b32 s27, s2, 8
  s_add_u32 s27, s27, 0x1e00000
  v_lshl_add_u32 v4, v0, 2, s27
  v_mov_b32 v5, 0
  global_store_dword v4, v5, s[8:9]
L_kb_nz:
  s_cmp_ge_u32 s24, 4
  s_cbranch_scc1 L_kb_loader
  s_branch L_kb_norm
L_kb_loader:
  s_setprio 3
  s_sub_u32 s33, s24, 4
  s_mov_b32 s27, 0xaaaaab
  v_lshlrev_b32 v12, 4, v0
  v_add_u32 v12, 0, v12
  v_mul_hi_u32 v13, v12, s27
  v_mul_u32_u24 v14, 384, v13
  v_sub_u32 v14, v12, v14
  v_lshrrev_b32 v15, 7, v14
  v_and_b32 v14, 127, v14
  v_bfe_u32 v12, v13, 1, 1
  v_lshlrev_b32 v12, 6, v12
  v_xor_b32 v14, v14, v12
  v_mul_u32_u24 v13, 3072, v13
  v_lshl_add_u32 v13, v15, 10, v13
  v_add_u32 v6, v13, v14
  v_lshlrev_b32 v12, 4, v0
  v_add_u32 v12, 1024, v12
  v_mul_hi_u32 v13, v12, s27
  v_mul_u32_u24 v14, 384, v13
  v_sub_u32 v14, v12, v14
  v_lshrrev_b32 v15, 7, v14
  v_and_b32 v14, 127, v14
  v_bfe_u32 v12, v13, 1, 1
  v_lshlrev_b32 v12, 6, v12
  v_xor_b32 v14, v14, v12
  v_mul_u32_u24 v13, 3072, v13
  v_lshl_add_u32 v13, v15, 10, v13
  v_add_u32 v7, v13, v14
  v_lshlrev_b32 v12, 4, v0
  v_add_u32 v12, 2048, v12
  v_mul_hi_u32 v13, v12, s27
  v_mul_u32_u24 v14, 384, v13
  v_sub_u32 v14, v12, v14
  v_lshrrev_b32 v15, 7, v14
  v_and_b32 v14, 127, v14
  v_bfe_u32 v12, v13, 1, 1
  v_lshlrev_b32 v12, 6, v12
  v_xor_b32 v14, v14, v12
  v_mul_u32_u24 v13, 3072, v13
  v_lshl_add_u32 v13, v15, 10, v13
  v_add_u32 v8, v13, v14
  s_mul_i32 s45, s33, 3072
  s_lshl_b32 s46, s33, 12
  s_mul_i32 s32, s33, 24576
  s_lshl_b32 s27, s26, 7
  s_add_u32 s32, s32, s27
  s_add_u32 s44, s32, 1572864
  s_mul_i32 s27, s37, 98304
  s_add_u32 s32, s32, s27
  s_add_u32 m0, s45, 68608
  s_nop 0
  buffer_load_dwordx4 v6, s[16:19], s32 offen lds
  s_add_u32 m0, m0, 1024
  s_nop 0
  buffer_load_dwordx4 v7, s[16:19], s32 offen lds
  s_add_u32 m0, m0, 1024
  s_nop 0
  buffer_load_dwordx4 v8, s[16:19], s32 offen lds
  s_add_u32 s32, s32, 98304
  s_cmp_ge_u32 s32, s44
  s_cselect_b32 s27, 1572864, 0
  s_sub_u32 s32, s32, s27
  s_add_u32 m0, s45, 84992
  s_nop 0
  buffer_load_dwordx4 v6, s[16:19], s32 offen lds
  s_add_u32 m0, m0, 1024
  s_nop 0
  buffer_load_dwordx4 v7, s[16:19], s32 offen lds
  s_add_u32 m0, m0, 1024
  s_nop 0
  buffer_load_dwordx4 v8, s[16:19], s32 offen lds
  s_add_u32 s32, s32, 98304
  s_cmp_ge_u32 s32, s44
  s_cselect_b32 s27, 1572864, 0
  s_sub_u32 s32, s32, s27
  v_lshrrev_b32 v12, 5, v0
  v_add_u32 v12, 0, v12
  v_bfe_u32 v13, v0, 2, 3
  v_xor_b32 v13, v13, v12
  v_lshlrev_b32 v13, 6, v13
  v_and_b32 v14, 3, v0
  v_lshl_add_u32 v13, v14, 4, v13
  v_lshrrev_b32 v12, 5, v0
  v_mul_u32_u24 v12, 3584, v12
  v_add_u32 v9, v12, v13
  v_lshrrev_b32 v12, 5, v0
  v_add_u32 v12, 2, v12
  v_bfe_u32 v13, v0, 2, 3
  v_xor_b32 v13, v13, v12
  v_lshlrev_b32 v13, 6, v13
  v_and_b32 v14, 3, v0
  v_lshl_add_u32 v13, v14, 4, v13
  v_lshrrev_b32 v12, 5, v0
  v_mul_u32_u24 v12, 3584, v12
  v_add_u32 v10, v12, v13
L_kb_norm:
  s_and_b32 s28, s24, 1
  s_lshl_b32 s27, s28, 15
  v_and_b32 v3, 15, v1
  v_xor_b32 v3, v3, v2
  v_lshlrev_b32 v3, 4, v3
  v_lshl_add_u32 v3, v1, 10, v3
  v_add_u32 v4, s27, v3
  s_lshr_b32 s36, s24, 1
  s_lshl_b32 s42, s36, 8
  v_xor_b32 v5, s42, v4
  s_cmp_ge_u32 s24, 4
  s_cbranch_scc1 L_kb_nwl
  s_waitcnt vmcnt(0)
L_kb_nwl:
  s_waitcnt vmcnt(6)
  s_barrier
  v_xor_b32 v60, 0, v5
  v_xor_b32 v61, 32, v5
  v_xor_b32 v62, 64, v5
  v_xor_b32 v63, 96, v5
  v_xor_b32 v64, 128, v5
  v_xor_b32 v65, 160, v5
  v_xor_b32 v66, 192, v5
  v_xor_b32 v67, 224, v5
  ds_read_b128 v[16:19], v60
  ds_read_b128 v[20:23], v61
  ds_read_b128 v[24:27], v62
  ds_read_b128 v[28:31], v63
  ds_read_b128 v[32:35], v64
  ds_read_b128 v[36:39], v65
  ds_read_b128 v[40:43], v66
  ds_read_b128 v[44:47], v67
  v_mov_b32 v48, 0
  v_mov_b32 v49, 0
  v_mov_b32 v50, 0
  v_mov_b32 v51, 0
  v_mov_b32 v52, 0x3f803f80
  s_waitcnt lgkmcnt(7)
  v_dot2c_f32_bf16 v48, v52, v16
  v_dot2c_f32_bf16 v50, v16, v16
  v_dot2c_f32_bf16 v49, v52, v17
  v_dot2c_f32_bf16 v51, v17, v17
  v_dot2c_f32_bf16 v48, v52, v18
  v_dot2c_f32_bf16 v50, v18, v18
  v_dot2c_f32_bf16 v49, v52, v19
  v_dot2c_f32_bf16 v51, v19, v19
  s_waitcnt lgkmcnt(6)
  v_dot2c_f32_bf16 v48, v52, v20
  v_dot2c_f32_bf16 v50, v20, v20
  v_dot2c_f32_bf16 v49, v52, v21
  v_dot2c_f32_bf16 v51, v21, v21
  v_dot2c_f32_bf16 v48, v52, v22
  v_dot2c_f32_bf16 v50, v22, v22
  v_dot2c_f32_bf16 v49, v52, v23
  v_dot2c_f32_bf16 v51, v23, v23
  s_waitcnt lgkmcnt(5)
  v_dot2c_f32_bf16 v48, v52, v24
  v_dot2c_f32_bf16 v50, v24, v24
  v_dot2c_f32_bf16 v49, v52, v25
  v_dot2c_f32_bf16 v51, v25, v25
  v_dot2c_f32_bf16 v48, v52, v26
  v_dot2c_f32_bf16 v50, v26, v26
  v_dot2c_f32_bf16 v49, v52, v27
  v_dot2c_f32_bf16 v51, v27, v27
  s_waitcnt lgkmcnt(4)
  v_dot2c_f32_bf16 v48, v52, v28
  v_dot2c_f32_bf16 v50, v28, v28
  v_dot2c_f32_bf16 v49, v52, v29
  v_dot2c_f32_bf16 v51, v29, v29
  v_dot2c_f32_bf16 v48, v52, v30
  v_dot2c_f32_bf16 v50, v30, v30
  v_dot2c_f32_bf16 v49, v52, v31
  v_dot2c_f32_bf16 v51, v31, v31
  s_waitcnt lgkmcnt(3)
  v_dot2c_f32_bf16 v48, v52, v32
  v_dot2c_f32_bf16 v50, v32, v32
  v_dot2c_f32_bf16 v49, v52, v33
  v_dot2c_f32_bf16 v51, v33, v33
  v_dot2c_f32_bf16 v48, v52, v34
  v_dot2c_f32_bf16 v50, v34, v34
  v_dot2c_f32_bf16 v49, v52, v35
  v_dot2c_f32_bf16 v51, v35, v35
  s_waitcnt lgkmcnt(2)
  v_dot2c_f32_bf16 v48, v52, v36
  v_dot2c_f32_bf16 v50, v36, v36
  v_dot2c_f32_bf16 v49, v52, v37
  v_dot2c_f32_bf16 v51, v37, v37
  v_dot2c_f32_bf16 v48, v52, v38
  v_dot2c_f32_bf16 v50, v38, v38
  v_dot2c_f32_bf16 v49, v52, v39
  v_dot2c_f32_bf16 v51, v39, v39
  s_waitcnt lgkmcnt(1)
  v_dot2c_f32_bf16 v48, v52, v40
  v_dot2c_f32_bf16 v50, v40, v40
  v_dot2c_f32_bf16 v49, v52, v41
  v_dot2c_f32_bf16 v51, v41, v41
  v_dot2c_f32_bf16 v48, v52, v42
  v_dot2c_f32_bf16 v50, v42, v42
  v_dot2c_f32_bf16 v49, v52, v43
  v_dot2c_f32_bf16 v51, v43, v43
  s_waitcnt lgkmcnt(0)
  v_dot2c_f32_bf16 v48, v52, v44
  v_dot2c_f32_bf16 v50, v44, v44
  v_dot2c_f32_bf16 v49, v52, v45
  v_dot2c_f32_bf16 v51, v45, v45
  v_dot2c_f32_bf16 v48, v52, v46
  v_dot2c_f32_bf16 v50, v46, v46
  v_dot2c_f32_bf16 v49, v52, v47
  v_dot2c_f32_bf16 v51, v47, v47
  s_nop 2
  v_add_f32 v48, v48, v49
  v_mov_b32 v49, v48
  s_nop 1
  v_permlane32_swap_b32 v49, v48
  s_nop 1
  v_add_f32 v48, v48, v49
  v_add_f32 v50, v50, v51
  v_mov_b32 v51, v50
  s_nop 1
  v_permlane32_swap_b32 v51, v50
  s_nop 1
  v_add_f32 v50, v50, v51
  s_cmp_ge_u32 s24, 4
  s_cbranch_scc0 L_kb_nnd
  s_add_u32 m0, s45, 101376
  s_nop 0
  buffer_load_dwordx4 v6, s[16:19], s32 offen lds
  s_add_u32 m0, m0, 1024
  s_nop 0
  buffer_load_dwordx4 v7, s[16:19], s32 offen lds
  s_add_u32 m0, m0, 1024
  s_nop 0
  buffer_load_dwordx4 v8, s[16:19], s32 offen lds
  s_add_u32 s32, s32, 98304
  s_cmp_ge_u32 s32, s44
  s_cselect_b32 s27, 1572864, 0
  s_sub_u32 s32, s32, s27
  s_add_u32 m0, s45, 117760
  s_nop 0
  buffer_load_dwordx4 v6, s[16:19], s32 offen lds
  s_add_u32 m0, m0, 1024
  s_nop 0
  buffer_load_dwordx4 v7, s[16:19], s32 offen lds
  s_add_u32 m0, m0, 1024
  s_nop 0
  buffer_load_dwordx4 v8, s[16:19], s32 offen lds
  s_add_u32 s32, s32, 98304
  s_cmp_ge_u32 s32, s44
  s_cselect_b32 s27, 1572864, 0
  s_sub_u32 s32, s32, s27
L_kb_nnd:
  v_mov_b32 v49, v50
  s_lshl_b32 s27, s24, 8
  s_add_u32 s27, s27, 65536
  v_lshl_add_u32 v3, v1, 3, s27
  ds_write_b64 v3, v[48:49]
  s_waitcnt lgkmcnt(0)
  s_barrier
  s_and_b32 s27, s24, 1
  s_lshl_b32 s27, s27, 8
  s_add_u32 s27, s27, 65536
  v_lshl_add_u32 v3, v1, 3, s27
  ds_read_b64 v[68:69], v3 offset:0
  ds_read_b64 v[70:71], v3 offset:512
  ds_read_b64 v[72:73], v3 offset:1024
  ds_read_b64 v[74:75], v3 offset:1536
  s_waitcnt lgkmcnt(0)
  v_add_f32 v68, v68, v70
  v_add_f32 v69, v69, v71
  v_add_f32 v72, v72, v74
  v_add_f32 v73, v73, v75
  v_add_f32 v48, v68, v72
  v_add_f32 v50, v69, v73
  v_mul_f32 v48, 0x3b000000, v48
  v_mul_f32 v50, 0x3b000000, v50
  v_fma_f32 v50, -v48, v48, v50
  v_max_f32 v50, 0, v50
  v_add_f32 v50, 0x3727c5ac, v50
  v_rsq_f32 v50, v50
  v_mov_b32 v76, 0xffff0000
  v_mul_f32 v48, v48, v50
  v_mov_b32 v51, v50
  v_sub_f32 v48, 0, v48
  v_mov_b32 v49, v48
  v_lshlrev_b32 v78, 16, v16
  v_and_b32 v79, v76, v16
  v_pk_fma_f32 v[78:79], v[78:79], v[50:51], v[48:49]
  v_lshlrev_b32 v80, 16, v17
  v_and_b32 v81, v76, v17
  v_cvt_pk_bf16_f32 v16, v78, v79
  v_pk_fma_f32 v[80:81], v[80:81], v[50:51], v[48:49]
  v_lshlrev_b32 v78, 16, v18
  v_and_b32 v79, v76, v18
  v_cvt_pk_bf16_f32 v17, v80, v81
  v_pk_fma_f32 v[78:79], v[78:79], v[50:51], v[48:49]
  v_lshlrev_b32 v80, 16, v19
  v_and_b32 v81, v76, v19
  v_cvt_pk_bf16_f32 v18, v78, v79
  v_pk_fma_f32 v[80:81], v[80:81], v[50:51], v[48:49]
  v_cvt_pk_bf16_f32 v19, v80, v81
  ds_write_b128 v60, v[16:19]
  v_lshlrev_b32 v78, 16, v20
  v_and_b32 v79, v76, v20
  v_pk_fma_f32 v[78:79], v[78:79], v[50:51], v[48:49]
  v_lshlrev_b32 v80, 16, v21
  v_and_b32 v81, v76, v21
  v_cvt_pk_bf16_f32 v20, v78, v79
  v_pk_fma_f32 v[80:81], v[80:81], v[50:51], v[48:49]
  v_lshlrev_b32 v78, 16, v22
  v_and_b32 v79, v76, v22
  v_cvt_pk_bf16_f32 v21, v80, v81
  v_pk_fma_f32 v[78:79], v[78:79], v[50:51], v[48:49]
  v_lshlrev_b32 v80, 16, v23
  v_and_b32 v81, v76, v23
  v_cvt_pk_bf16_f32 v22, v78, v79
  v_pk_fma_f32 v[80:81], v[80:81], v[50:51], v[48:49]
  v_cvt_pk_bf16_f32 v23, v80, v81
  ds_write_b128 v61, v[20:23]
  v_lshlrev_b32 v78, 16, v24
  v_and_b32 v79, v76, v24
  v_pk_fma_f32 v[78:79], v[78:79], v[50:51], v[48:49]
  v_lshlrev_b32 v80, 16, v25
  v_and_b32 v81, v76, v25
  v_cvt_pk_bf16_f32 v24, v78, v79
  v_pk_fma_f32 v[80:81], v[80:81], v[50:51], v[48:49]
  v_lshlrev_b32 v78, 16, v26
  v_and_b32 v79, v76, v26
  v_cvt_pk_bf16_f32 v25, v80, v81
  v_pk_fma_f32 v[78:79], v[78:79], v[50:51], v[48:49]
  v_lshlrev_b32 v80, 16, v27
  v_and_b32 v81, v76, v27
  v_cvt_pk_bf16_f32 v26, v78, v79
  v_pk_fma_f32 v[80:81], v[80:81], v[50:51], v[48:49]
  v_cvt_pk_bf16_f32 v27, v80, v81
  ds_write_b128 v62, v[24:27]
  v_lshlrev_b32 v78, 16, v28
  v_and_b32 v79, v76, v28
  v_pk_fma_f32 v[78:79], v[78:79], v[50:51], v[48:49]
  v_lshlrev_b32 v80, 16, v29
  v_and_b32 v81, v76, v29
  v_cvt_pk_bf16_f32 v28, v78, v79
  v_pk_fma_f32 v[80:81], v[80:81], v[50:51], v[48:49]
  v_lshlrev_b32 v78, 16, v30
  v_and_b32 v79, v76, v30
  v_cvt_pk_bf16_f32 v29, v80, v81
  v_pk_fma_f32 v[78:79], v[78:79], v[50:51], v[48:49]
  v_lshlrev_b32 v80, 16, v31
  v_and_b32 v81, v76, v31
  v_cvt_pk_bf16_f32 v30, v78, v79
  v_pk_fma_f32 v[80:81], v[80:81], v[50:51], v[48:49]
  v_cvt_pk_bf16_f32 v31, v80, v81
  ds_write_b128 v63, v[28:31]
  v_lshlrev_b32 v78, 16, v32
  v_and_b32 v79, v76, v32
  v_pk_fma_f32 v[78:79], v[78:79], v[50:51], v[48:49]
  v_lshlrev_b32 v80, 16, v33
  v_and_b32 v81, v76, v33
  v_cvt_pk_bf16_f32 v32, v78, v79
  v_pk_fma_f32 v[80:81], v[80:81], v[50:51], v[48:49]
  v_lshlrev_b32 v78, 16, v34
  v_and_b32 v79, v76, v34
  v_cvt_pk_bf16_f32 v33, v80, v81
  v_pk_fma_f32 v[78:79], v[78:79], v[50:51], v[48:49]
  v_lshlrev_b32 v80, 16, v35
  v_and_b32 v81, v76, v35
  v_cvt_pk_bf16_f32 v34, v78, v79
  v_pk_fma_f32 v[80:81], v[80:81], v[50:51], v[48:49]
  v_cvt_pk_bf16_f32 v35, v80, v81
  ds_write_b128 v64, v[32:35]
  v_lshlrev_b32 v78, 16, v36
  v_and_b32 v79, v76, v36
  v_pk_fma_f32 v[78:79], v[78:79], v[50:51], v[48:49]
  v_lshlrev_b32 v80, 16, v37
  v_and_b32 v81, v76, v37
  v_cvt_pk_bf16_f32 v36, v78, v79
  v_pk_fma_f32 v[80:81], v[80:81], v[50:51], v[48:49]
  v_lshlrev_b32 v78, 16, v38
  v_and_b32 v79, v76, v38
  v_cvt_pk_bf16_f32 v37, v80, v81
  v_pk_fma_f32 v[78:79], v[78:79], v[50:51], v[48:49]
  v_lshlrev_b32 v80, 16, v39
  v_and_b32 v81, v76, v39
  v_cvt_pk_bf16_f32 v38, v78, v79
  v_pk_fma_f32 v[80:81], v[80:81], v[50:51], v[48:49]
  v_cvt_pk_bf16_f32 v39, v80, v81
  ds_write_b128 v65, v[36:39]
  v_lshlrev_b32 v78, 16, v40
  v_and_b32 v79, v76, v40
  v_pk_fma_f32 v[78:79], v[78:79], v[50:51], v[48:49]
  v_lshlrev_b32 v80, 16, v41
  v_and_b32 v81, v76, v41
  v_cvt_pk_bf16_f32 v40, v78, v79
  v_pk_fma_f32 v[80:81], v[80:81], v[50:51], v[48:49]
  v_lshlrev_b32 v78, 16, v42
  v_and_b32 v79, v76, v42
  v_cvt_pk_bf16_f32 v41, v80, v81
  v_pk_fma_f32 v[78:79], v[78:79], v[50:51], v[48:49]
  v_lshlrev_b32 v80, 16, v43
  v_and_b32 v81, v76, v43
  v_cvt_pk_bf16_f32 v42, v78, v79
  v_pk_fma_f32 v[80:81], v[80:81], v[50:51], v[48:49]
  v_cvt_pk_bf16_f32 v43, v80, v81
  ds_write_b128 v66, v[40:43]
  v_lshlrev_b32 v78, 16, v44
  v_and_b32 v79, v76, v44
  v_pk_fma_f32 v[78:79], v[78:79], v[50:51], v[48:49]
  v_lshlrev_b32 v80, 16, v45
  v_and_b32 v81, v76, v45
  v_cvt_pk_bf16_f32 v44, v78, v79
  v_pk_fma_f32 v[80:81], v[80:81], v[50:51], v[48:49]
  v_lshlrev_b32 v78, 16, v46
  v_and_b32 v79, v76, v46
  v_cvt_pk_bf16_f32 v45, v80, v81
  v_pk_fma_f32 v[78:79], v[78:79], v[50:51], v[48:49]
  v_lshlrev_b32 v80, 16, v47
  v_and_b32 v81, v76, v47
  v_cvt_pk_bf16_f32 v46, v78, v79
  v_pk_fma_f32 v[80:81], v[80:81], v[50:51], v[48:49]
  v_cvt_pk_bf16_f32 v47, v80, v81
  ds_write_b128 v67, v[44:47]
  s_lshr_b32 s27, s26, 1
  s_lshr_b32 s28, s24, 1
  s_cmp_eq_u32 s27, s28
  s_cbranch_scc0 L_kb_noxn
  s_and_b32 s27, s24, 1
  s_lshl_b32 s28, s25, 1
  s_add_u32 s27, s27, s28
  s_lshl_b32 s27, s27, 15
  s_lshl_b32 s28, s26, 12
  s_add_u32 s27, s27, s28
  s_add_u32 s27, s27, 0x1400000
  v_lshlrev_b32 v3, 4, v0
  s_bitcmp1_b32 s26, 0
  s_cbranch_scc1 L_kb_xnhi
  buffer_store_dwordx4 v[16:19], v3, s[20:23], s27 offen offset:0 sc1
  buffer_store_dwordx4 v[20:23], v3, s[20:23], s27 offen offset:1024 sc1
  buffer_store_dwordx4 v[24:27], v3, s[20:23], s27 offen offset:2048 sc1
  buffer_store_dwordx4 v[28:31], v3, s[20:23], s27 offen offset:3072 sc1
  s_branch L_kb_noxn
L_kb_xnhi:
  buffer_store_dwordx4 v[32:35], v3, s[20:23], s27 offen offset:0 sc1
  buffer_store_dwordx4 v[36:39], v3, s[20:23], s27 offen offset:1024 sc1
  buffer_store_dwordx4 v[40:43], v3, s[20:23], s27 offen offset:2048 sc1
  buffer_store_dwordx4 v[44:47], v3, s[20:23], s27 offen offset:3072 sc1
L_kb_noxn:
  s_waitcnt lgkmcnt(0)
  s_cmp_ge_u32 s24, 4
  s_cbranch_scc1 L_kb_lpost
  s_lshr_b32 s27, s24, 1
  v_bfe_u32 v60, v0, 2, 2
  v_and_b32 v61, 3, v0
  v_bfe_u32 v62, v0, 4, 1
  v_lshl_add_u32 v61, v62, 2, v61
  v_and_b32 v62, 1, v61
  v_lshrrev_b32 v63, 1, v61
  v_lshl_add_u32 v64, v2, 3, v60
  v_lshl_add_u32 v61, v62, 2, v63
  v_mul_u32_u24 v65, 384, v64
  v_lshl_add_u32 v65, v61, 3, v65
  v_lshrrev_b32 v61, 1, v60
  v_xor_b32 v61, s27, v61
  v_lshl_add_u32 v6, v61, 6, v65
  v_lshrrev_b32 v61, 1, v63
  v_and_b32 v63, 1, v63
  v_lshl_add_u32 v63, v62, 1, v63
  v_lshl_add_u32 v61, v61, 2, v63
  v_lshlrev_b32 v65, 9, v64
  v_lshl_add_u32 v65, v61, 3, v65
  s_lshl_b32 s27, s27, 8
  v_add_u32 v65, s27, v65
  v_xor_b32 v61, 0, v60
  v_lshl_add_u32 v7, v61, 6, v65
  v_xor_b32 v61, 1, v60
  v_lshl_add_u32 v8, v61, 6, v65
  v_xor_b32 v61, 2, v60
  v_lshl_add_u32 v9, v61, 6, v65
  v_xor_b32 v61, 3, v60
  v_lshl_add_u32 v10, v61, 6, v65
  s_and_b32 s28, s24, 1
  s_lshl_b32 s27, s28, 15
  v_and_b32 v3, 15, v1
  v_xor_b32 v3, v3, v2
  v_lshlrev_b32 v3, 4, v3
  v_lshl_add_u32 v3, v1, 10, v3
  v_add_u32 v4, s27, v3
  v_mov_b32 v60, 0
  v_mov_b32 v61, 0
  v_mov_b32 v62, 0
  v_mov_b32 v63, 0
  v_mov_b32 v64, 0
  v_mov_b32 v65, 0
  v_mov_b32 v66, 0
  v_mov_b32 v67, 0
  v_mov_b32 v68, 0
  v_mov_b32 v69, 0
  v_mov_b32 v70, 0
  v_mov_b32 v71, 0
  v_mov_b32 v72, 0
  v_mov_b32 v73, 0
  v_mov_b32 v74, 0
  v_mov_b32 v75, 0
  v_mov_b32 v76, 0
  v_mov_b32 v77, 0
  v_mov_b32 v78, 0
  v_mov_b32 v79, 0
  v_mov_b32 v80, 0
  v_mov_b32 v81, 0
  v_mov_b32 v82, 0
  v_mov_b32 v83, 0
  v_mov_b32 v84, 0
  v_mov_b32 v85, 0
  v_mov_b32 v86, 0
  v_mov_b32 v87, 0
  v_mov_b32 v88, 0
  v_mov_b32 v89, 0
  v_mov_b32 v90, 0
  v_mov_b32 v91, 0
  v_mov_b32 v92, 0
  v_mov_b32 v93, 0
  v_mov_b32 v94, 0
  v_mov_b32 v95, 0
  v_mov_b32 v96, 0
  v_mov_b32 v97, 0
  v_mov_b32 v98, 0
  v_mov_b32 v99, 0
  v_mov_b32 v100, 0
  v_mov_b32 v101, 0
  v_mov_b32 v102, 0
  v_mov_b32 v103, 0
  v_mov_b32 v104, 0
  v_mov_b32 v105, 0
  v_mov_b32 v106, 0
  v_mov_b32 v107, 0
  s_mov_b32 s30, 68608
  s_setprio 2
  s_barrier
  s_mov_b32 s39, s37
  s_lshl_b32 s42, s39, 6
  v_add_u32 v11, s30, v6
  v_xor_b32 v19, s42, v4
  ds_read_b128 v[20:23], v19
  ds_read_b64_tr_b16 v[28:29], v11 offset:0
  ds_read_b64_tr_b16 v[30:31], v11 offset:1536
  ds_read_b64_tr_b16 v[32:33], v11 offset:128
  ds_read_b64_tr_b16 v[34:35], v11 offset:1664
  ds_read_b64_tr_b16 v[36:37], v11 offset:256
  ds_read_b64_tr_b16 v[38:39], v11 offset:1792
  v_xor_b32 v19, 32, v19
  s_mov_b32 s29, 0
.p2align 3
L_kbQ_loop:
  s_waitcnt lgkmcnt(4)
  v_mfma_f32_32x32x16_bf16 v[60:75], v[28:31], v[20:23], v[60:75]
  ds_read_b128 v[24:27], v19
  ds_read_b64_tr_b16 v[44:45], v11 offset:6144
  ds_read_b64_tr_b16 v[46:47], v11 offset:7680
  s_add_u32 s39, s39, 1
  s_and_b32 s39, s39, 15
  s_lshl_b32 s42, s39, 6
  v_xor_b32 v19, s42, v4
  s_waitcnt lgkmcnt(5)
  v_mfma_f32_32x32x16_bf16 v[76:91], v[32:35], v[20:23], v[76:91]
  ds_read_b64_tr_b16 v[48:49], v11 offset:6272
  ds_read_b64_tr_b16 v[50:51], v11 offset:7808
  s_add_u32 s30, s30, 16384
  s_cmp_ge_u32 s30, 150528
  s_cselect_b32 s30, 68608, s30
  s_waitcnt lgkmcnt(5)
  v_mfma_f32_32x32x16_bf16 v[92:107], v[20:23], v[36:39], v[92:107]
  ds_read_b64_tr_b16 v[52:53], v11 offset:6400
  ds_read_b64_tr_b16 v[54:55], v11 offset:7936
  v_add_u32 v15, s30, v6
  s_waitcnt lgkmcnt(4)
  v_mfma_f32_32x32x16_bf16 v[60:75], v[44:47], v[24:27], v[60:75]
  s_barrier
  ds_read_b128 v[20:23], v19
  ds_read_b64_tr_b16 v[28:29], v15 offset:0
  ds_read_b64_tr_b16 v[30:31], v15 offset:1536
  v_xor_b32 v19, 32, v19
  s_waitcnt lgkmcnt(5)
  v_mfma_f32_32x32x16_bf16 v[76:91], v[48:51], v[24:27], v[76:91]
  ds_read_b64_tr_b16 v[32:33], v15 offset:128
  ds_read_b64_tr_b16 v[34:35], v15 offset:1664
  s_waitcnt lgkmcnt(5)
  v_mfma_f32_32x32x16_bf16 v[92:107], v[24:27], v[52:55], v[92:107]
  ds_read_b64_tr_b16 v[36:37], v15 offset:256
  ds_read_b64_tr_b16 v[38:39], v15 offset:1792
  s_waitcnt lgkmcnt(4)
  v_mfma_f32_32x32x16_bf16 v[60:75], v[28:31], v[20:23], v[60:75]
  ds_read_b128 v[24:27], v19
  ds_read_b64_tr_b16 v[44:45], v15 offset:6144
  ds_read_b64_tr_b16 v[46:47], v15 offset:7680
  s_add_u32 s39, s39, 1
  s_and_b32 s39, s39, 15
  s_lshl_b32 s42, s39, 6
  v_xor_b32 v19, s42, v4
  s_waitcnt lgkmcnt(5)
  v_mfma_f32_32x32x16_bf16 v[76:91], v[32:35], v[20:23], v[76:91]
  ds_read_b64_tr_b16 v[48:49], v15 offset:6272
  ds_read_b64_tr_b16 v[50:51], v15 offset:7808
  s_add_u32 s30, s30, 16384
  s_cmp_ge_u32 s30, 150528
  s_cselect_b32 s30, 68608, s30
  s_waitcnt lgkmcnt(5)
  v_mfma_f32_32x32x16_bf16 v[92:107], v[20:23], v[36:39], v[92:107]
  ds_read_b64_tr_b16 v[52:53], v15 offset:6400
  ds_read_b64_tr_b16 v[54:55], v15 offset:7936
  v_add_u32 v11, s30, v6
  s_waitcnt lgkmcnt(4)
  v_mfma_f32_32x32x16_bf16 v[60:75], v[44:47], v[24:27], v[60:75]
  s_barrier
  ds_read_b128 v[20:23], v19
  ds_read_b64_tr_b16 v[28:29], v11 offset:0
  ds_read_b64_tr_b16 v[30:31], v11 offset:1536
  v_xor_b32 v19, 32, v19
  s_waitcnt lgkmcnt(5)
  v_mfma_f32_32x32x16_bf16 v[76:91], v[48:51], v[24:27], v[76:91]
  ds_read_b64_tr_b16 v[32:33], v11 offset:128
  ds_read_b64_tr_b16 v[34:35], v11 offset:1664
  s_waitcnt lgkmcnt(5)
  v_mfma_f32_32x32x16_bf16 v[92:107], v[24:27], v[52:55], v[92:107]
  ds_read_b64_tr_b16 v[36:37], v11 offset:256
  ds_read_b64_tr_b16 v[38:39], v11 offset:1792
  s_add_u32 s29, s29, 1
  s_cmp_lt_u32 s29, 8
  s_cbranch_scc1 L_kbQ_loop
  s_waitcnt lgkmcnt(0)
  s_nop 7
  s_lshl_b32 s28, s25, 1
  s_and_b32 s27, s24, 1
  s_add_u32 s28, s28, s27
  s_lshl_b32 s36, s26, 2
  s_and_b32 s27, s24, 2
  s_add_u32 s36, s36, s27
  v_add_u32 v15, s36, v2
  v_lshlrev_b32 v16, 4, v1
  v_lshl_add_u32 v12, v15, 16, v16
  s_lshl_b32 s27, s28, 10
  v_add_u32 v12, s27, v12
  v_lshl_add_u32 v13, v15, 17, v16
  s_lshl_b32 s27, s28, 11
  s_add_u32 s27, s27, 0x200000
  v_add_u32 v13, s27, v13
  v_bfe_u32 v15, v1, 2, 1
  v_lshrrev_b32 v16, 3, v1
  v_and_b32 v14, 3, v1
  v_and_b32 v17, 1, v16
  v_lshrrev_b32 v16, 1, v16
  v_lshl_add_u32 v14, v16, 2, v14
  v_lshl_add_u32 v14, v17, 3, v14
  v_lshlrev_b32 v14, 4, v14
  v_add_u32 v15, s36, v15
  v_lshl_add_u32 v14, v15, 17, v14
  v_lshl_add_u32 v14, v2, 8, v14
  s_add_u32 s27, s27, 1024
  v_add_u32 v14, s27, v14
  v_cvt_pk_bf16_f32 v76, v76, v77
  v_cvt_pk_bf16_f32 v77, v78, v79
  v_cvt_pk_bf16_f32 v78, v80, v81
  v_cvt_pk_bf16_f32 v79, v82, v83
  v_cvt_pk_bf16_f32 v80, v84, v85
  v_cvt_pk_bf16_f32 v81, v86, v87
  v_cvt_pk_bf16_f32 v82, v88, v89
  v_cvt_pk_bf16_f32 v83, v90, v91
  buffer_store_dwordx4 v[76:79], v13, s[20:23], 0 offen sc1
  buffer_store_dwordx4 v[80:83], v13, s[20:23], 0 offen offset:512 sc1
  v_cvt_pk_bf16_f32 v92, v92, v93
  v_cvt_pk_bf16_f32 v93, v94, v95
  v_cvt_pk_bf16_f32 v94, v96, v97
  v_cvt_pk_bf16_f32 v95, v98, v99
  v_cvt_pk_bf16_f32 v96, v100, v101
  v_cvt_pk_bf16_f32 v97, v102, v103
  v_cvt_pk_bf16_f32 v98, v104, v105
  v_cvt_pk_bf16_f32 v99, v106, v107
  buffer_store_dwordx4 v[92:95], v14, s[20:23], 0 offen sc1
  buffer_store_dwordx4 v[96:99], v14, s[20:23], 0 offen offset:512 sc1
  v_mul_f32 v60, 0x3eb8aa3b, v60
  v_mul_f32 v61, 0x3eb8aa3b, v61
  v_mul_f32 v62, 0x3eb8aa3b, v62
  v_mul_f32 v63, 0x3eb8aa3b, v63
  v_mul_f32 v64, 0x3eb8aa3b, v64
  v_mul_f32 v65, 0x3eb8aa3b, v65
  v_mul_f32 v66, 0x3eb8aa3b, v66
  v_mul_f32 v67, 0x3eb8aa3b, v67
  v_mul_f32 v68, 0x3eb8aa3b, v68
  v_mul_f32 v69, 0x3eb8aa3b, v69
  v_mul_f32 v70, 0x3eb8aa3b, v70
  v_mul_f32 v71, 0x3eb8aa3b, v71
  v_mul_f32 v72, 0x3eb8aa3b, v72
  v_mul_f32 v73, 0x3eb8aa3b, v73
  v_mul_f32 v74, 0x3eb8aa3b, v74
  v_mul_f32 v75, 0x3eb8aa3b, v75
  v_cvt_pk_bf16_f32 v60, v60, v61
  v_cvt_pk_bf16_f32 v61, v62, v63
  v_cvt_pk_bf16_f32 v62, v64, v65
  v_cvt_pk_bf16_f32 v63, v66, v67
  v_cvt_pk_bf16_f32 v64, v68, v69
  v_cvt_pk_bf16_f32 v65, v70, v71
  v_cvt_pk_bf16_f32 v66, v72, v73
  v_cvt_pk_bf16_f32 v67, v74, v75
  buffer_store_dwordx4 v[60:63], v12, s[20:23], 0 offen sc1
  buffer_store_dwordx4 v[64:67], v12, s[20:23], 0 offen offset:512 sc1
  s_waitcnt vmcnt(0)
  s_endpgm
L_kb_lpost:
  s_waitcnt vmcnt(9)
  s_barrier
  s_setprio 3
  s_waitcnt vmcnt(6)
  s_barrier
  s_add_u32 m0, s45, 134144
  s_nop 0
  buffer_load_dwordx4 v6, s[16:19], s32 offen lds
  s_add_u32 m0, m0, 1024
  s_nop 0
  buffer_load_dwordx4 v7, s[16:19], s32 offen lds
  s_add_u32 m0, m0, 1024
  s_nop 0
  buffer_load_dwordx4 v8, s[16:19], s32 offen lds
  s_add_u32 s32, s32, 98304
  s_cmp_ge_u32 s32, s44
  s_cselect_b32 s27, 1572864, 0
  s_sub_u32 s32, s32, s27
  s_waitcnt vmcnt(6)
  s_barrier
  s_add_u32 m0, s45, 68608
  s_nop 0
  buffer_load_dwordx4 v6, s[16:19], s32 offen lds
  s_add_u32 m0, m0, 1024
  s_nop 0
  buffer_load_dwordx4 v7, s[16:19], s32 offen lds
  s_add_u32 m0, m0, 1024
  s_nop 0
  buffer_load_dwordx4 v8, s[16:19], s32 offen lds
  s_add_u32 s32, s32, 98304
  s_cmp_ge_u32 s32, s44
  s_cselect_b32 s27, 1572864, 0
  s_sub_u32 s32, s32, s27
  s_waitcnt vmcnt(6)
  s_barrier
  s_add_u32 m0, s45, 84992
  s_nop 0
  buffer_load_dwordx4 v6, s[16:19], s32 offen lds
  s_add_u32 m0, m0, 1024
  s_nop 0
  buffer_load_dwordx4 v7, s[16:19], s32 offen lds
  s_add_u32 m0, m0, 1024
  s_nop 0
  buffer_load_dwordx4 v8, s[16:19], s32 offen lds
  s_add_u32 s32, s32, 98304
  s_cmp_ge_u32 s32, s44
  s_cselect_b32 s27, 1572864, 0
  s_sub_u32 s32, s32, s27
  s_waitcnt vmcnt(6)
  s_barrier
  s_add_u32 m0, s45, 101376
  s_nop 0
  buffer_load_dwordx4 v6, s[16:19], s32 offen lds
  s_add_u32 m0, m0, 1024
  s_nop 0
  buffer_load_dwordx4 v7, s[16:19], s32 offen lds
  s_add_u32 m0, m0, 1024
  s_nop 0
  buffer_load_dwordx4 v8, s[16:19], s32 offen lds
  s_add_u32 s32, s32, 98304
  s_cmp_ge_u32 s32, s44
  s_cselect_b32 s27, 1572864, 0
  s_sub_u32 s32, s32, s27
  s_waitcnt vmcnt(6)
  s_barrier
  s_add_u32 m0, s45, 117760
  s_nop 0
  buffer_load_dwordx4 v6, s[16:19], s32 offen lds
  s_add_u32 m0, m0, 1024
  s_nop 0
  buffer_load_dwordx4 v7, s[16:19], s32 offen lds
  s_add_u32 m0, m0, 1024
  s_nop 0
  buffer_load_dwordx4 v8, s[16:19], s32 offen lds
  s_add_u32 s32, s32, 98304
  s_cmp_ge_u32 s32, s44
  s_cselect_b32 s27, 1572864, 0
  s_sub_u32 s32, s32, s27
  s_waitcnt vmcnt(6)
  s_barrier
  s_add_u32 m0, s45, 134144
  s_nop 0
  buffer_load_dwordx4 v6, s[16:19], s32 offen lds
  s_add_u32 m0, m0, 1024
  s_nop 0
  buffer_load_dwordx4 v7, s[16:19], s32 offen lds
  s_add_u32 m0, m0, 1024
  s_nop 0
  buffer_load_dwordx4 v8, s[16:19], s32 offen lds
  s_add_u32 s32, s32, 98304
  s_cmp_ge_u32 s32, s44
  s_cselect_b32 s27, 1572864, 0
  s_sub_u32 s32, s32, s27
  s_waitcnt vmcnt(6)
  s_barrier
  s_add_u32 m0, s45, 68608
  s_nop 0
  buffer_load_dwordx4 v6, s[16:19], s32 offen lds
  s_add_u32 m0, m0, 1024
  s_nop 0
  buffer_load_dwordx4 v7, s[16:19], s32 offen lds
  s_add_u32 m0, m0, 1024
  s_nop 0
  buffer_load_dwordx4 v8, s[16:19], s32 offen lds
  s_add_u32 s32, s32, 98304
  s_cmp_ge_u32 s32, s44
  s_cselect_b32 s27, 1572864, 0
  s_sub_u32 s32, s32, s27
  s_waitcnt vmcnt(6)
  s_barrier
  s_add_u32 m0, s45, 84992
  s_nop 0
  buffer_load_dwordx4 v6, s[16:19], s32 offen lds
  s_add_u32 m0, m0, 1024
  s_nop 0
  buffer_load_dwordx4 v7, s[16:19], s32 offen lds
  s_add_u32 m0, m0, 1024
  s_nop 0
  buffer_load_dwordx4 v8, s[16:19], s32 offen lds
  s_add_u32 s32, s32, 98304
  s_cmp_ge_u32 s32, s44
  s_cselect_b32 s27, 1572864, 0
  s_sub_u32 s32, s32, s27
  s_waitcnt vmcnt(6)
  s_barrier
  s_add_u32 m0, s45, 101376
  s_nop 0
  buffer_load_dwordx4 v6, s[16:19], s32 offen lds
  s_add_u32 m0, m0, 1024
  s_nop 0
  buffer_load_dwordx4 v7, s[16:19], s32 offen lds
  s_add_u32 m0, m0, 1024
  s_nop 0
  buffer_load_dwordx4 v8, s[16:19], s32 offen lds
  s_add_u32 s32, s32, 98304
  s_cmp_ge_u32 s32, s44
  s_cselect_b32 s27, 1572864, 0
  s_sub_u32 s32, s32, s27
  s_waitcnt vmcnt(6)
  s_barrier
  s_add_u32 m0, s45, 117760
  s_nop 0
  buffer_load_dwordx4 v6, s[16:19], s32 offen lds
  s_add_u32 m0, m0, 1024
  s_nop 0
  buffer_load_dwordx4 v7, s[16:19], s32 offen lds
  s_add_u32 m0, m0, 1024
  s_nop 0
  buffer_load_dwordx4 v8, s[16:19], s32 offen lds
  s_add_u32 s32, s32, 98304
  s_cmp_ge_u32 s32, s44
  s_cselect_b32 s27, 1572864, 0
  s_sub_u32 s32, s32, s27
  s_waitcnt vmcnt(6)
  s_barrier
  s_add_u32 m0, s45, 134144
  s_nop 0
  buffer_load_dwordx4 v6, s[16:19], s32 offen lds
  s_add_u32 m0, m0, 1024
  s_nop 0
  buffer_load_dwordx4 v7, s[16:19], s32 offen lds
  s_add_u32 m0, m0, 1024
  s_nop 0
  buffer_load_dwordx4 v8, s[16:19], s32 offen lds
  s_add_u32 s32, s32, 98304
  s_cmp_ge_u32 s32, s44
  s_cselect_b32 s27, 1572864, 0
  s_sub_u32 s32, s32, s27
  s_waitcnt vmcnt(6)
  s_barrier
  s_add_u32 m0, s45, 68608
  s_nop 0
  buffer_load_dwordx4 v6, s[16:19], s32 offen lds
  s_add_u32 m0, m0, 1024
  s_nop 0
  buffer_load_dwordx4 v7, s[16:19], s32 offen lds
  s_add_u32 m0, m0, 1024
  s_nop 0
  buffer_load_dwordx4 v8, s[16:19], s32 offen lds
  s_add_u32 s32, s32, 98304
  s_cmp_ge_u32 s32, s44
  s_cselect_b32 s27, 1572864, 0
  s_sub_u32 s32, s32, s27
  s_waitcnt vmcnt(6)
  s_barrier
  s_waitcnt vmcnt(3)
  s_barrier
  s_waitcnt vmcnt(0)
  s_barrier
  s_waitcnt vmcnt(0)
  s_barrier
L_kb_lend:
  s_waitcnt vmcnt(0)
  s_endpgm
L_kb_exit:
  s_endpgm
.section .rodata,"a"
.p2align 6
.amdhsa_kernel kb_kernel
  .amdhsa_next_free_vgpr 128
  .amdhsa_next_free_sgpr 96
  .amdhsa_accum_offset 128
  .amdhsa_group_segment_fixed_size 0
  .amdhsa_kernarg_size 88
  .amdhsa_user_sgpr_count 2
  .amdhsa_user_sgpr_kernarg_segment_ptr 1
  .amdhsa_system_sgpr_workgroup_id_x 1
  .amdhsa_float_denorm_mode_32 3
.end_amdhsa_kernel
.text
.text
.globl k2_kernel
.p2align 8
.type k2_kernel,@function
k2_kernel:
  s_cmp_ge_u32 s2, 512
  s_cbranch_scc1 L_attn_exit
  s_cmp_ge_u32 s2, 256
  s_cbranch_scc1 L_attn_role2
  s_load_dwordx2 s[4:5], s[0:1], 80
  s_load_dwordx2 s[34:35], s[0:1], 72
  s_setprio 3
  s_and_b32 s17, s2, 7
  s_lshl_b32 s17, s17, 2
  s_lshr_b32 s19, s2, 3
  s_and_b32 s19, s19, 3
  s_add_u32 s17, s17, s19
  s_lshr_b32 s18, s2, 5
  v_lshrrev_b32 v6, 6, v0
  v_and_b32 v0, 63, v0
  v_readfirstlane_b32 s16, v6
  v_lshlrev_b32 v1, 4, v0
  v_mov_b32 v4, v1
  v_lshrrev_b32 v6, 5, v0
  v_lshlrev_b32 v6, 8, v6
  v_and_b32 v7, 15, v0
  v_lshlrev_b32 v7, 4, v7
  v_add3_u32 v5, v6, v7, 0
  v_add_u32 v5, 1024, v5
  s_mov_b32 s22, 0x0000ffff
  s_mov_b32 s23, 0x0000ffff
  s_waitcnt lgkmcnt(0)
  s_lshl_b32 s19, s17, 17
  s_add_u32 s8, s4, s19
  s_addc_u32 s9, s5, 0
  s_add_u32 s8, s8, 0x200000
  s_addc_u32 s9, s9, 0
  s_and_b32 s9, s9, 0xffff
  s_mov_b32 s10, 0x20000
  s_mov_b32 s11, 0x20000
  s_mov_b32 s24, s16
  s_mov_b32 s32, 0
  s_mul_i32 s19, s16, 3072
  s_add_u32 s19, s19, s32
  s_mov_b32 m0, s19
  s_lshl_b32 s19, s24, 11
  buffer_load_dwordx4 v4, s[8:11], s19 offen lds
  s_add_u32 m0, m0, 1024
  s_mov_b64 exec, s[22:23]
  buffer_load_dwordx4 v5, s[8:11], s19 offen lds
  s_add_u32 m0, m0, 512
  s_nop 0
  buffer_load_dwordx4 v5, s[8:11], s19 offen offset:512 lds
  s_mov_b64 exec, -1
  s_mov_b32 s12, s4
  s_and_b32 s13, s5, 0xffff
  s_mov_b32 s14, 0x1100000
  s_mov_b32 s15, 0x20000
  s_lshl_b32 s19, s17, 6
  s_lshl_b32 s28, s18, 3
  s_add_u32 s28, s28, s16
  s_add_u32 s19, s19, s28
  s_lshl_b32 s19, s19, 10
  buffer_load_dwordx4 v[84:87], v1, s[12:15], s19 offen
  s_mul_i32 s28, s28, 144
  s_add_u32 s28, s28, s17
  s_add_u32 s28, s28, 112
  s_lshl_b32 s28, s28, 10
  s_add_u32 s28, s28, 0x800000
  v_mov_b32 v64, 0x3f803f80
  v_mov_b32 v65, 0x3f803f80
  v_mov_b32 v66, 0x3f803f80
  v_mov_b32 v67, 0x3f803f80
  s_mul_i32 s19, s16, 3072
  v_add_u32 v6, s19, v1
  v_and_b32 v7, 27, v0
  v_cmp_eq_u32 vcc, 16, v7
  s_nop 1
  v_cndmask_b32 v64, 0, v64, vcc
  v_cndmask_b32 v65, 0, v65, vcc
  v_cndmask_b32 v66, 0, v66, vcc
  v_cndmask_b32 v67, 0, v67, vcc
  s_mov_b32 exec_lo, 0xffff0000
  s_mov_b32 exec_hi, 0xffff0000
  ds_write_b128 v6, v[64:67] offset:1024
  ds_write_b128 v6, v[64:67] offset:2048
  ds_write_b128 v6, v[64:67] offset:25600
  ds_write_b128 v6, v[64:67] offset:26624
  ds_write_b128 v6, v[64:67] offset:50176
  ds_write_b128 v6, v[64:67] offset:51200
  s_mov_b64 exec, -1
  s_add_u32 s24, s24, 8
  s_mov_b32 s32, 24576
  s_mul_i32 s19, s16, 3072
  s_add_u32 s19, s19, s32
  s_mov_b32 m0, s19
  s_lshl_b32 s19, s24, 11
  buffer_load_dwordx4 v4, s[8:11], s19 offen lds
  s_add_u32 m0, m0, 1024
  s_mov_b64 exec, s[22:23]
  buffer_load_dwordx4 v5, s[8:11], s19 offen lds
  s_add_u32 m0, m0, 512
  s_nop 0
  buffer_load_dwordx4 v5, s[8:11], s19 offen offset:512 lds
  s_mov_b64 exec, -1
  s_waitcnt vmcnt(3) lgkmcnt(0)
  s_barrier
  ds_read_b128 v[72:75], v1 offset:0
  ds_read_b128 v[76:79], v1 offset:3072
  ds_read_b128 v[80:83], v1 offset:6144
  ds_read_b128 v[64:67], v1 offset:9216
  s_waitcnt lgkmcnt(3)
  v_mfma_f32_32x32x16_bf16 v[16:31], v[72:75], v[84:87], 0
  s_waitcnt lgkmcnt(2)
  v_mfma_f32_32x32x16_bf16 v[32:47], v[76:79], v[84:87], 0
  s_waitcnt lgkmcnt(1)
  v_mfma_f32_32x32x16_bf16 v[48:63], v[80:83], v[84:87], 0
  s_waitcnt lgkmcnt(0)
  v_mfma_f32_32x32x16_bf16 v[96:111], v[64:67], v[84:87], 0
  s_nop 7
  v_max3_f32 v6, v16, v17, v18
  v_max3_f32 v6, v6, v19, v20
  v_max3_f32 v6, v6, v21, v22
  v_max3_f32 v6, v6, v23, v24
  v_max3_f32 v6, v6, v25, v26
  v_max3_f32 v6, v6, v27, v28
  v_max3_f32 v6, v6, v29, v30
  v_max3_f32 v6, v6, v31, v32
  v_max3_f32 v6, v6, v33, v34
  v_max3_f32 v6, v6, v35, v36
  v_max3_f32 v6, v6, v37, v38
  v_max3_f32 v6, v6, v39, v40
  v_max3_f32 v6, v6, v41, v42
  v_max3_f32 v6, v6, v43, v44
  v_max3_f32 v6, v6, v45, v46
  v_max3_f32 v6, v6, v47, v48
  v_max3_f32 v6, v6, v49, v50
  v_max3_f32 v6, v6, v51, v52
  v_max3_f32 v6, v6, v53, v54
  v_max3_f32 v6, v6, v55, v56
  v_max3_f32 v6, v6, v57, v58
  v_max3_f32 v6, v6, v59, v60
  v_max3_f32 v6, v6, v61, v62
  v_max3_f32 v6, v6, v63, v96
  v_max3_f32 v6, v6, v97, v98
  v_max3_f32 v6, v6, v99, v100
  v_max3_f32 v6, v6, v101, v102
  v_max3_f32 v6, v6, v103, v104
  v_max3_f32 v6, v6, v105, v106
  v_max3_f32 v6, v6, v107, v108
  v_max3_f32 v6, v6, v109, v110
  v_max_f32 v6, v6, v111
  v_mov_b32 v7, v6
  s_nop 1
  v_permlane32_swap_b32 v7, v6
  s_nop 1
  v_max_f32 v6, v6, v7
  v_add_f32 v6, 0x42c80000, v6
  v_sub_f32 v48, 0, v6
  v_sub_f32 v49, 0, v6
  v_sub_f32 v50, 0, v6
  v_sub_f32 v51, 0, v6
  v_sub_f32 v52, 0, v6
  v_sub_f32 v53, 0, v6
  v_sub_f32 v54, 0, v6
  v_sub_f32 v55, 0, v6
  v_sub_f32 v56, 0, v6
  v_sub_f32 v57, 0, v6
  v_sub_f32 v58, 0, v6
  v_sub_f32 v59, 0, v6
  v_sub_f32 v60, 0, v6
  v_sub_f32 v61, 0, v6
  v_sub_f32 v62, 0, v6
  v_sub_f32 v63, 0, v6
  v_mov_b32 v96, 0
  v_mov_b32 v97, 0
  v_mov_b32 v98, 0
  v_mov_b32 v99, 0
  v_mov_b32 v100, 0
  v_mov_b32 v101, 0
  v_mov_b32 v102, 0
  v_mov_b32 v103, 0
  v_mov_b32 v104, 0
  v_mov_b32 v105, 0
  v_mov_b32 v106, 0
  v_mov_b32 v107, 0
  v_mov_b32 v108, 0
  v_mov_b32 v109, 0
  v_mov_b32 v110, 0
  v_mov_b32 v111, 0
  v_mov_b32 v68, 0
  v_mov_b32 v80, 0
  v_mov_b32 v69, 0
  v_mov_b32 v81, 0
  v_mov_b32 v70, 0
  v_mov_b32 v82, 0
  v_mov_b32 v71, 0
  v_mov_b32 v83, 0
  s_waitcnt lgkmcnt(0)
  v_mfma_f32_32x32x16_bf16 v[16:31], v[72:75], v[84:87], v[48:63]
  ds_read_b128 v[72:75], v1 offset:3072
  ds_read_b128 v[76:79], v1 offset:1024
  v_mov_b32 v2, v1
  v_add_u32 v3, 24576, v1
  s_mov_b32 s20, 0
  s_mov_b32 s32, 49152
  s_waitcnt lgkmcnt(0)
  s_nop 7
.p2align 6
L_attn_chunk:
  s_setprio 2
  s_waitcnt lgkmcnt(0)
  v_mfma_f32_32x32x16_bf16 v[32:47], v[72:75], v[84:87], v[48:63]
  ds_read_b128 v[112:115], v2 offset:2048
  v_exp_f32 v16, v16
  v_exp_f32 v17, v17
  ds_read_b128 v[92:95], v2 offset:4096
  v_exp_f32 v18, v18
  v_exp_f32 v19, v19
  v_mfma_f32_32x32x16_bf16 v[96:111], v[80:83], v[68:71], v[96:111]
  ds_read_b128 v[88:91], v2 offset:6144
  v_cvt_pk_bf16_f32 v64, v16, v17
  v_exp_f32 v20, v20
  v_exp_f32 v21, v21
  v_cvt_pk_bf16_f32 v65, v18, v19
  v_exp_f32 v22, v22
  v_exp_f32 v23, v23
  v_cvt_pk_bf16_f32 v66, v20, v21
  v_exp_f32 v24, v24
  v_cvt_pk_bf16_f32 v67, v22, v23
  v_exp_f32 v25, v25
  v_exp_f32 v26, v26
  v_mfma_f32_32x32x16_bf16 v[96:111], v[76:79], v[64:67], v[96:111]
  v_exp_f32 v27, v27
  v_cvt_pk_bf16_f32 v68, v24, v25
  v_exp_f32 v28, v28
  v_exp_f32 v29, v29
  v_cvt_pk_bf16_f32 v69, v26, v27
  v_exp_f32 v30, v30
  v_exp_f32 v31, v31
  v_cvt_pk_bf16_f32 v70, v28, v29
  v_cvt_pk_bf16_f32 v71, v30, v31
  s_waitcnt lgkmcnt(0)
  v_mfma_f32_32x32x16_bf16 v[16:31], v[88:91], v[84:87], v[48:63]
  ds_read_b128 v[80:83], v2 offset:5120
  v_exp_f32 v32, v32
  v_exp_f32 v33, v33
  ds_read_b128 v[76:79], v2 offset:7168
  v_exp_f32 v34, v34
  v_exp_f32 v35, v35
  v_mfma_f32_32x32x16_bf16 v[96:111], v[112:115], v[68:71], v[96:111]
  ds_read_b128 v[72:75], v2 offset:9216
  v_cvt_pk_bf16_f32 v64, v32, v33
  v_exp_f32 v36, v36
  v_exp_f32 v37, v37
  v_cvt_pk_bf16_f32 v65, v34, v35
  v_exp_f32 v38, v38
  v_exp_f32 v39, v39
  v_cvt_pk_bf16_f32 v66, v36, v37
  v_exp_f32 v40, v40
  v_cvt_pk_bf16_f32 v67, v38, v39
  v_exp_f32 v41, v41
  v_exp_f32 v42, v42
  v_mfma_f32_32x32x16_bf16 v[96:111], v[92:95], v[64:67], v[96:111]
  v_exp_f32 v43, v43
  v_cvt_pk_bf16_f32 v68, v40, v41
  v_exp_f32 v44, v44
  v_exp_f32 v45, v45
  v_cvt_pk_bf16_f32 v69, v42, v43
  v_exp_f32 v46, v46
  v_exp_f32 v47, v47
  v_cvt_pk_bf16_f32 v70, v44, v45
  v_cvt_pk_bf16_f32 v71, v46, v47
  s_setprio 1
  s_waitcnt lgkmcnt(0)
  v_mfma_f32_32x32x16_bf16 v[32:47], v[72:75], v[84:87], v[48:63]
  ds_read_b128 v[112:115], v2 offset:8192
  v_exp_f32 v16, v16
  v_exp_f32 v17, v17
  ds_read_b128 v[92:95], v2 offset:10240
  v_exp_f32 v18, v18
  v_exp_f32 v19, v19
  v_mfma_f32_32x32x16_bf16 v[96:111], v[80:83], v[68:71], v[96:111]
  ds_read_b128 v[88:91], v2 offset:12288
  v_cvt_pk_bf16_f32 v64, v16, v17
  v_exp_f32 v20, v20
  v_exp_f32 v21, v21
  v_cvt_pk_bf16_f32 v65, v18, v19
  v_exp_f32 v22, v22
  v_exp_f32 v23, v23
  v_cvt_pk_bf16_f32 v66, v20, v21
  v_exp_f32 v24, v24
  v_cvt_pk_bf16_f32 v67, v22, v23
  v_exp_f32 v25, v25
  v_exp_f32 v26, v26
  v_mfma_f32_32x32x16_bf16 v[96:111], v[76:79], v[64:67], v[96:111]
  v_exp_f32 v27, v27
  v_cvt_pk_bf16_f32 v68, v24, v25
  v_exp_f32 v28, v28
  v_exp_f32 v29, v29
  v_cvt_pk_bf16_f32 v69, v26, v27
  v_exp_f32 v30, v30
  v_exp_f32 v31, v31
  v_cvt_pk_bf16_f32 v70, v28, v29
  v_cvt_pk_bf16_f32 v71, v30, v31
  s_waitcnt lgkmcnt(0)
  v_mfma_f32_32x32x16_bf16 v[16:31], v[88:91], v[84:87], v[48:63]
  ds_read_b128 v[80:83], v2 offset:11264
  v_exp_f32 v32, v32
  v_exp_f32 v33, v33
  ds_read_b128 v[76:79], v2 offset:13312
  v_exp_f32 v34, v34
  v_exp_f32 v35, v35
  v_mfma_f32_32x32x16_bf16 v[96:111], v[112:115], v[68:71], v[96:111]
  ds_read_b128 v[72:75], v2 offset:15360
  v_cvt_pk_bf16_f32 v64, v32, v33
  v_exp_f32 v36, v36
  v_exp_f32 v37, v37
  v_cvt_pk_bf16_f32 v65, v34, v35
  v_exp_f32 v38, v38
  v_exp_f32 v39, v39
  v_cvt_pk_bf16_f32 v66, v36, v37
  v_exp_f32 v40, v40
  v_cvt_pk_bf16_f32 v67, v38, v39
  v_exp_f32 v41, v41
  v_exp_f32 v42, v42
  v_mfma_f32_32x32x16_bf16 v[96:111], v[92:95], v[64:67], v[96:111]
  v_exp_f32 v43, v43
  v_cvt_pk_bf16_f32 v68, v40, v41
  v_exp_f32 v44, v44
  v_exp_f32 v45, v45
  v_cvt_pk_bf16_f32 v69, v42, v43
  v_exp_f32 v46, v46
  v_exp_f32 v47, v47
  v_cvt_pk_bf16_f32 v70, v44, v45
  v_cvt_pk_bf16_f32 v71, v46, v47
  s_waitcnt vmcnt(0)
  s_barrier
  s_cmp_ge_u32 s20, 6
  s_cbranch_scc1 L_attn_nodma
  s_add_u32 s24, s24, 8
  s_mul_i32 s19, s16, 3072
  s_add_u32 s19, s19, s32
  s_mov_b32 m0, s19
  s_lshl_b32 s19, s24, 11
  buffer_load_dwordx4 v4, s[8:11], s19 offen lds
  s_add_u32 m0, m0, 1024
  s_mov_b64 exec, s[22:23]
  buffer_load_dwordx4 v5, s[8:11], s19 offen lds
  s_add_u32 m0, m0, 512
  s_nop 0
  buffer_load_dwordx4 v5, s[8:11], s19 offen offset:512 lds
  s_mov_b64 exec, -1
L_attn_nodma:
  s_setprio 3
  s_waitcnt lgkmcnt(0)
  v_mfma_f32_32x32x16_bf16 v[32:47], v[72:75], v[84:87], v[48:63]
  ds_read_b128 v[112:115], v2 offset:14336
  v_exp_f32 v16, v16
  v_exp_f32 v17, v17
  ds_read_b128 v[92:95], v2 offset:16384
  v_exp_f32 v18, v18
  v_exp_f32 v19, v19
  v_mfma_f32_32x32x16_bf16 v[96:111], v[80:83], v[68:71], v[96:111]
  ds_read_b128 v[88:91], v2 offset:18432
  v_cvt_pk_bf16_f32 v64, v16, v17
  v_exp_f32 v20, v20
  v_exp_f32 v21, v21
  v_cvt_pk_bf16_f32 v65, v18, v19
  v_exp_f32 v22, v22
  v_exp_f32 v23, v23
  v_cvt_pk_bf16_f32 v66, v20, v21
  v_exp_f32 v24, v24
  v_cvt_pk_bf16_f32 v67, v22, v23
  v_exp_f32 v25, v25
  v_exp_f32 v26, v26
  v_mfma_f32_32x32x16_bf16 v[96:111], v[76:79], v[64:67], v[96:111]
  v_exp_f32 v27, v27
  v_cvt_pk_bf16_f32 v68, v24, v25
  v_exp_f32 v28, v28
  v_exp_f32 v29, v29
  v_cvt_pk_bf16_f32 v69, v26, v27
  v_exp_f32 v30, v30
  v_exp_f32 v31, v31
  v_cvt_pk_bf16_f32 v70, v28, v29
  v_cvt_pk_bf16_f32 v71, v30, v31
  s_waitcnt lgkmcnt(0)
  v_mfma_f32_32x32x16_bf16 v[16:31], v[88:91], v[84:87], v[48:63]
  ds_read_b128 v[80:83], v2 offset:17408
  v_exp_f32 v32, v32
  v_exp_f32 v33, v33
  ds_read_b128 v[76:79], v2 offset:19456
  v_exp_f32 v34, v34
  v_exp_f32 v35, v35
  v_mfma_f32_32x32x16_bf16 v[96:111], v[112:115], v[68:71], v[96:111]
  ds_read_b128 v[72:75], v2 offset:21504
  v_cvt_pk_bf16_f32 v64, v32, v33
  v_exp_f32 v36, v36
  v_exp_f32 v37, v37
  v_cvt_pk_bf16_f32 v65, v34, v35
  v_exp_f32 v38, v38
  v_exp_f32 v39, v39
  v_cvt_pk_bf16_f32 v66, v36, v37
  v_exp_f32 v40, v40
  v_cvt_pk_bf16_f32 v67, v38, v39
  v_exp_f32 v41, v41
  v_exp_f32 v42, v42
  v_mfma_f32_32x32x16_bf16 v[96:111], v[92:95], v[64:67], v[96:111]
  v_exp_f32 v43, v43
  v_cvt_pk_bf16_f32 v68, v40, v41
  v_exp_f32 v44, v44
  v_exp_f32 v45, v45
  v_cvt_pk_bf16_f32 v69, v42, v43
  v_exp_f32 v46, v46
  v_exp_f32 v47, v47
  v_cvt_pk_bf16_f32 v70, v44, v45
  v_cvt_pk_bf16_f32 v71, v46, v47
  s_waitcnt lgkmcnt(0)
  v_mfma_f32_32x32x16_bf16 v[32:47], v[72:75], v[84:87], v[48:63]
  ds_read_b128 v[112:115], v2 offset:20480
  v_exp_f32 v16, v16
  v_exp_f32 v17, v17
  ds_read_b128 v[92:95], v2 offset:22528
  v_exp_f32 v18, v18
  v_exp_f32 v19, v19
  v_mfma_f32_32x32x16_bf16 v[96:111], v[80:83], v[68:71], v[96:111]
  ds_read_b128 v[88:91], v3 offset:0
  v_cvt_pk_bf16_f32 v64, v16, v17
  v_exp_f32 v20, v20
  v_exp_f32 v21, v21
  v_cvt_pk_bf16_f32 v65, v18, v19
  v_exp_f32 v22, v22
  v_exp_f32 v23, v23
  v_cvt_pk_bf16_f32 v66, v20, v21
  v_exp_f32 v24, v24
  v_cvt_pk_bf16_f32 v67, v22, v23
  v_exp_f32 v25, v25
  v_exp_f32 v26, v26
  v_mfma_f32_32x32x16_bf16 v[96:111], v[76:79], v[64:67], v[96:111]
  v_exp_f32 v27, v27
  v_cvt_pk_bf16_f32 v68, v24, v25
  v_exp_f32 v28, v28
  v_exp_f32 v29, v29
  v_cvt_pk_bf16_f32 v69, v26, v27
  v_exp_f32 v30, v30
  v_exp_f32 v31, v31
  v_cvt_pk_bf16_f32 v70, v28, v29
  v_cvt_pk_bf16_f32 v71, v30, v31
  s_waitcnt lgkmcnt(0)
  v_mfma_f32_32x32x16_bf16 v[16:31], v[88:91], v[84:87], v[48:63]
  ds_read_b128 v[80:83], v2 offset:23552
  v_exp_f32 v32, v32
  v_exp_f32 v33, v33
  ds_read_b128 v[76:79], v3 offset:1024
  v_exp_f32 v34, v34
  v_exp_f32 v35, v35
  v_mfma_f32_32x32x16_bf16 v[96:111], v[112:115], v[68:71], v[96:111]
  ds_read_b128 v[72:75], v3 offset:3072
  v_cvt_pk_bf16_f32 v64, v32, v33
  v_exp_f32 v36, v36
  v_exp_f32 v37, v37
  v_cvt_pk_bf16_f32 v65, v34, v35
  v_exp_f32 v38, v38
  v_exp_f32 v39, v39
  v_cvt_pk_bf16_f32 v66, v36, v37
  v_exp_f32 v40, v40
  v_cvt_pk_bf16_f32 v67, v38, v39
  v_exp_f32 v41, v41
  v_exp_f32 v42, v42
  v_mfma_f32_32x32x16_bf16 v[96:111], v[92:95], v[64:67], v[96:111]
  v_exp_f32 v43, v43
  v_cvt_pk_bf16_f32 v68, v40, v41
  v_exp_f32 v44, v44
  v_exp_f32 v45, v45
  v_cvt_pk_bf16_f32 v69, v42, v43
  v_exp_f32 v46, v46
  v_exp_f32 v47, v47
  v_cvt_pk_bf16_f32 v70, v44, v45
  v_cvt_pk_bf16_f32 v71, v46, v47
  v_mov_b32 v2, v3
  v_add_u32 v3, s32, v1
  s_add_u32 s32, s32, 24576
  s_cmp_ge_u32 s32, 73728
  s_cselect_b32 s32, 0, s32
  s_add_u32 s20, s20, 1
  s_cmp_lt_u32 s20, 8
  s_cbranch_scc1 L_attn_chunk
  s_waitcnt lgkmcnt(0)
  v_mfma_f32_32x32x16_bf16 v[96:111], v[80:83], v[68:71], v[96:111]
  s_nop 15
  v_mul_f32 v6, 0, v96
  v_fma_f32 v6, v97, 0, v6
  v_fma_f32 v6, v98, 0, v6
  v_fma_f32 v6, v99, 0, v6
  v_fma_f32 v6, v100, 0, v6
  v_fma_f32 v6, v101, 0, v6
  v_fma_f32 v6, v102, 0, v6
  v_fma_f32 v6, v103, 0, v6
  s_mov_b32 s19, 0x76800000
  v_cmp_ngt_f32 vcc, s19, v104
  v_cmp_u_f32 s[20:21], v6, v6
  s_nop 1
  s_or_b64 vcc, vcc, s[20:21]
  s_cbranch_vccnz L_attn_slow
L_attn_fin:
  v_rcp_f32 v6, v104
  s_nop 0
  v_mul_f32 v96, v96, v6
  v_mul_f32 v97, v97, v6
  v_mul_f32 v98, v98, v6
  v_mul_f32 v99, v99, v6
  v_mul_f32 v100, v100, v6
  v_mul_f32 v101, v101, v6
  v_mul_f32 v102, v102, v6
  v_mul_f32 v103, v103, v6
  v_cvt_pk_bf16_f32 v64, v96, v97
  v_cvt_pk_bf16_f32 v65, v98, v99
  v_cvt_pk_bf16_f32 v66, v100, v101
  v_cvt_pk_bf16_f32 v67, v102, v103
  buffer_store_dwordx4 v[64:67], v1, s[12:15], s28 offen sc1
  s_lshl_b32 s19, s18, 3
  s_add_u32 s19, s19, s16
  s_lshl_b32 s19, s19, 5
  s_add_u32 s19, s19, s17
  s_lshl_b32 s19, s19, 2
  s_add_u32 s19, s19, 0x1e00000
  v_mov_b32 v6, s19
  v_mov_b32 v7, 1
  s_waitcnt vmcnt(0)
  s_mov_b64 exec, 1
  global_store_dword v6, v7, s[4:5] sc1
  s_mov_b64 exec, -1
L_attn_nosig:
  s_waitcnt vmcnt(0)
  s_endpgm
L_attn_slow:
  v_mov_b32 v6, 0xff800000
  s_mov_b32 s20, 0
L_attn_slow_max:
  buffer_load_dwordx4 v[72:75], v4, s[8:11], s20 offen
  s_waitcnt vmcnt(0)
  v_mfma_f32_32x32x16_bf16 v[16:31], v[72:75], v[84:87], 0
  s_nop 15
  v_max3_f32 v6, v6, v16, v17
  v_max3_f32 v6, v6, v18, v19
  v_max3_f32 v6, v6, v20, v21
  v_max3_f32 v6, v6, v22, v23
  v_max3_f32 v6, v6, v24, v25
  v_max3_f32 v6, v6, v26, v27
  v_max3_f32 v6, v6, v28, v29
  v_max3_f32 v6, v6, v30, v31
  s_add_u32 s20, s20, 2048
  s_cmp_lt_u32 s20, 0x20000
  s_cbranch_scc1 L_attn_slow_max
  v_mov_b32 v7, v6
  s_nop 1
  v_permlane32_swap_b32 v7, v6
  s_nop 1
  v_max_f32 v6, v6, v7
  v_sub_f32 v48, 0, v6
  v_mov_b32 v96, 0
  v_sub_f32 v49, 0, v6
  v_mov_b32 v97, 0
  v_sub_f32 v50, 0, v6
  v_mov_b32 v98, 0
  v_sub_f32 v51, 0, v6
  v_mov_b32 v99, 0
  v_sub_f32 v52, 0, v6
  v_mov_b32 v100, 0
  v_sub_f32 v53, 0, v6
  v_mov_b32 v101, 0
  v_sub_f32 v54, 0, v6
  v_mov_b32 v102, 0
  v_sub_f32 v55, 0, v6
  v_mov_b32 v103, 0
  v_sub_f32 v56, 0, v6
  v_mov_b32 v104, 0
  v_sub_f32 v57, 0, v6
  v_mov_b32 v105, 0
  v_sub_f32 v58, 0, v6
  v_mov_b32 v106, 0
  v_sub_f32 v59, 0, v6
  v_mov_b32 v107, 0
  v_sub_f32 v60, 0, v6
  v_mov_b32 v108, 0
  v_sub_f32 v61, 0, v6
  v_mov_b32 v109, 0
  v_sub_f32 v62, 0, v6
  v_mov_b32 v110, 0
  v_sub_f32 v63, 0, v6
  v_mov_b32 v111, 0
  v_mov_b32 v76, 0x3f803f80
  v_mov_b32 v80, 0x3f803f80
  v_mov_b32 v77, 0x3f803f80
  v_mov_b32 v81, 0x3f803f80
  v_mov_b32 v78, 0x3f803f80
  v_mov_b32 v82, 0x3f803f80
  v_mov_b32 v79, 0x3f803f80
  v_mov_b32 v83, 0x3f803f80
  s_mov_b32 s20, 0
L_attn_slow_pv:
  buffer_load_dwordx4 v[72:75], v4, s[8:11], s20 offen
  s_mov_b64 exec, s[22:23]
  buffer_load_dwordx4 v[76:79], v5, s[8:11], s20 offen
  buffer_load_dwordx4 v[80:83], v5, s[8:11], s20 offen offset:512
  s_mov_b64 exec, -1
  s_waitcnt vmcnt(0)
  v_mfma_f32_32x32x16_bf16 v[16:31], v[72:75], v[84:87], v[48:63]
  s_nop 15
  v_exp_f32 v16, v16
  v_exp_f32 v17, v17
  v_exp_f32 v18, v18
  v_exp_f32 v19, v19
  v_exp_f32 v20, v20
  v_exp_f32 v21, v21
  v_exp_f32 v22, v22
  v_exp_f32 v23, v23
  v_exp_f32 v24, v24
  v_exp_f32 v25, v25
  v_exp_f32 v26, v26
  v_exp_f32 v27, v27
  v_exp_f32 v28, v28
  v_exp_f32 v29, v29
  v_exp_f32 v30, v30
  v_exp_f32 v31, v31
  s_nop 0
  v_cvt_pk_bf16_f32 v64, v16, v17
  v_cvt_pk_bf16_f32 v65, v18, v19
  v_cvt_pk_bf16_f32 v66, v20, v21
  v_cvt_pk_bf16_f32 v67, v22, v23
  v_cvt_pk_bf16_f32 v68, v24, v25
  v_cvt_pk_bf16_f32 v69, v26, v27
  v_cvt_pk_bf16_f32 v70, v28, v29
  v_cvt_pk_bf16_f32 v71, v30, v31
  s_nop 1
  v_mfma_f32_32x32x16_bf16 v[96:111], v[76:79], v[64:67], v[96:111]
  v_mfma_f32_32x32x16_bf16 v[96:111], v[80:83], v[68:71], v[96:111]
  s_add_u32 s20, s20, 2048
  s_cmp_lt_u32 s20, 0x20000
  s_cbranch_scc1 L_attn_slow_pv
  s_nop 15
  s_branch L_attn_fin
L_attn_role2:
  v_lshrrev_b32 v1, 6, v0
  v_and_b32 v0, 63, v0
  v_readfirstlane_b32 s36, v1
  s_load_dwordx2 s[14:15], s[0:1], 80
  s_load_dwordx2 s[6:7], s[0:1], 48
  s_load_dwordx2 s[8:9], s[0:1], 16
  s_load_dwordx2 s[4:5], s[0:1], 0
  s_load_dwordx2 s[10:11], s[0:1], 56
  s_load_dwordx2 s[12:13], s[0:1], 64
  s_sub_u32 s3, s2, 256
  s_load_dwordx2 s[62:63], s[0:1], 32
  s_load_dwordx2 s[64:65], s[0:1], 40
  s_bfe_u32 s49, s3, 0x30003
  s_bfe_u32 s37, s3, 0x20001
  s_lshl_b32 s37, s37, 3
  s_add_u32 s37, s37, s49
  s_and_b32 s38, s3, 1
  s_lshl_b32 s38, s38, 2
  s_lshr_b32 s39, s3, 6
  s_and_b32 s39, s39, 3
  s_add_u32 s38, s38, s39
  v_and_b32 v1, 31, v0
  v_lshrrev_b32 v2, 5, v0
  s_waitcnt lgkmcnt(0)
  s_mov_b32 s16, s14
  s_and_b32 s17, s15, 0xffff
  s_mov_b32 s18, 0x1600000
  s_mov_b32 s19, 0x20000
  s_setprio 3
  s_lshl_b32 s59, s49, 1
  s_and_b32 s39, s38, 3
  s_lshl_b32 s39, s39, 2
  s_add_u32 s59, s59, s39
  s_and_b32 s59, s59, 15
  s_mov_b32 s68, s62
  s_and_b32 s69, s63, 0xffff
  s_mov_b32 s70, 0x1c0000
  s_mov_b32 s71, 0x20000
  s_cmp_ge_u32 s36, 4
  s_cbranch_scc0 L_g2f_cmp
  s_sub_u32 s72, s36, 4
  s_and_b32 s76, s72, 1
  s_lshl_b32 s39, s76, 2
  s_mov_b32 s40, 0x924925
  s_add_u32 s77, s39, 0
  s_lshl_b32 s77, s77, 10
  v_lshl_add_u32 v12, v0, 4, s77
  v_mul_hi_u32 v13, v12, s40
  v_mul_u32_u24 v14, 448, v13
  v_sub_u32 v14, v12, v14
  v_mul_u32_u24 v13, 3584, v13
  v_add_u32 v8, v13, v14
  s_add_u32 s77, s39, 1
  s_lshl_b32 s77, s77, 10
  v_lshl_add_u32 v12, v0, 4, s77
  v_mul_hi_u32 v13, v12, s40
  v_mul_u32_u24 v14, 448, v13
  v_sub_u32 v14, v12, v14
  v_mul_u32_u24 v13, 3584, v13
  v_add_u32 v9, v13, v14
  s_add_u32 s77, s39, 2
  s_lshl_b32 s77, s77, 10
  v_lshl_add_u32 v12, v0, 4, s77
  v_mul_hi_u32 v13, v12, s40
  v_mul_u32_u24 v14, 448, v13
  v_sub_u32 v14, v12, v14
  v_mul_u32_u24 v13, 3584, v13
  v_add_u32 v10, v13, v14
  s_add_u32 s77, s39, 3
  s_lshl_b32 s77, s77, 10
  v_lshl_add_u32 v12, v0, 4, s77
  v_mul_hi_u32 v13, v12, s40
  v_mul_u32_u24 v14, 448, v13
  v_sub_u32 v14, v12, v14
  v_mul_u32_u24 v13, 3584, v13
  v_add_u32 v11, v13, v14
  s_lshr_b32 s77, s72, 1
  s_mul_i32 s66, s77, 7168
  s_lshl_b32 s39, s39, 10
  s_add_u32 s66, s66, s39
  s_mul_i32 s73, s77, 57344
  s_mul_i32 s39, s38, 448
  s_add_u32 s73, s73, s39
  s_add_u32 s74, s73, 1835008
  s_mul_i32 s39, s59, 114688
  s_add_u32 s73, s73, s39
  s_lshl_b32 s39, s37, 1
  s_add_u32 s39, s39, s77
  s_lshl_b32 s78, s39, 15
  s_add_u32 s78, s78, 0x1400000
  s_lshl_b32 s39, s59, 11
  s_add_u32 s79, s78, s39
  s_lshl_b32 s39, s77, 11
  s_add_u32 s39, s39, 14336
  s_add_u32 s40, s66, 3072
  s_cmp_eq_u32 s76, 0
  s_cselect_b32 s61, s40, s39
  s_cselect_b32 s92, s68, s16
  s_cselect_b32 s93, s69, s17
  s_cselect_b32 s94, s70, s18
  s_mov_b32 s95, 0x20000
  s_cselect_b32 s67, s73, s79
  s_movk_i32 s90, 2048
  s_cselect_b32 s90, 114688, s90
  s_add_u32 s39, s78, 32768
  s_cmp_eq_u32 s76, 0
  s_cselect_b32 s91, s74, s39
  s_mov_b32 s60, 32768
  s_cselect_b32 s60, 1835008, s60
  v_lshlrev_b32 v12, 4, v0
  s_cselect_b64 vcc, -1, 0
  v_cndmask_b32 v11, v12, v11, vcc
  v_lshrrev_b32 v12, 3, v1
  v_bfe_u32 v13, v1, 2, 1
  v_and_b32 v14, 3, v1
  v_lshrrev_b32 v15, 1, v12
  v_and_b32 v12, 1, v12
  v_lshl_add_u32 v14, v12, 2, v14
  v_lshl_add_u32 v14, v13, 3, v14
  v_lshl_add_u32 v14, v15, 4, v14
  v_lshl_add_u32 v14, v2, 5, v14
  s_mul_i32 s39, s38, 224
  s_lshl_b32 s40, s72, 6
  s_add_u32 s39, s39, s40
  v_add_u32 v14, s39, v14
  v_lshlrev_b32 v14, 1, v14
  v_min_u32 v14, 3582, v14
  global_load_ushort v15, v14, s[64:65]
  s_add_u32 m0, s66, 0
  s_nop 0
  buffer_load_dwordx4 v8, s[68:71], s73 offen lds
  s_add_u32 m0, m0, 1024
  s_nop 0
  buffer_load_dwordx4 v9, s[68:71], s73 offen lds
  s_add_u32 m0, m0, 1024
  s_nop 0
  buffer_load_dwordx4 v10, s[68:71], s73 offen lds
  s_add_u32 m0, s61, 0
  s_cmp_eq_u32 s76, 0
  buffer_load_dwordx4 v11, s[92:95], s67 offen lds
  s_cbranch_scc1 L_g2f_ea
  buffer_load_dwordx4 v11, s[92:95], s67 offen offset:1024 lds
L_g2f_ea:
  s_add_u32 s73, s73, 114688
  s_cmp_ge_u32 s73, s74
  s_cselect_b32 s39, 1835008, 0
  s_sub_u32 s73, s73, s39
  s_add_u32 s67, s67, s90
  s_cmp_ge_u32 s67, s91
  s_cselect_b32 s39, s60, 0
  s_sub_u32 s67, s67, s39
  s_add_u32 m0, s66, 18432
  s_nop 0
  buffer_load_dwordx4 v8, s[68:71], s73 offen lds
  s_add_u32 m0, m0, 1024
  s_nop 0
  buffer_load_dwordx4 v9, s[68:71], s73 offen lds
  s_add_u32 m0, m0, 1024
  s_nop 0
  buffer_load_dwordx4 v10, s[68:71], s73 offen lds
  s_add_u32 m0, s61, 18432
  s_cmp_eq_u32 s76, 0
  buffer_load_dwordx4 v11, s[92:95], s67 offen lds
  s_cbranch_scc1 L_g2f_eb
  buffer_load_dwordx4 v11, s[92:95], s67 offen offset:1024 lds
L_g2f_eb:
  s_add_u32 s73, s73, 114688
  s_cmp_ge_u32 s73, s74
  s_cselect_b32 s39, 1835008, 0
  s_sub_u32 s73, s73, s39
  s_add_u32 s67, s67, s90
  s_cmp_ge_u32 s67, s91
  s_cselect_b32 s39, s60, 0
  s_sub_u32 s67, s67, s39
  s_waitcnt vmcnt(4)
  v_lshlrev_b32 v15, 16, v15
  s_lshl_b32 s39, s72, 8
  s_add_u32 s39, s39, 73728
  v_lshl_add_u32 v12, v0, 2, s39
  ds_write_b32 v12, v15
  s_waitcnt lgkmcnt(0)
  s_barrier
  s_add_u32 m0, s66, 36864
  s_nop 0
  buffer_load_dwordx4 v8, s[68:71], s73 offen lds
  s_add_u32 m0, m0, 1024
  s_nop 0
  buffer_load_dwordx4 v9, s[68:71], s73 offen lds
  s_add_u32 m0, m0, 1024
  s_nop 0
  buffer_load_dwordx4 v10, s[68:71], s73 offen lds
  s_add_u32 m0, s61, 36864
  s_cmp_eq_u32 s76, 0
  buffer_load_dwordx4 v11, s[92:95], s67 offen lds
  s_cbranch_scc1 L_g2f_ec
  buffer_load_dwordx4 v11, s[92:95], s67 offen offset:1024 lds
L_g2f_ec:
  s_add_u32 s73, s73, 114688
  s_cmp_ge_u32 s73, s74
  s_cselect_b32 s39, 1835008, 0
  s_sub_u32 s73, s73, s39
  s_add_u32 s67, s67, s90
  s_cmp_ge_u32 s67, s91
  s_cselect_b32 s39, s60, 0
  s_sub_u32 s67, s67, s39
  s_waitcnt vmcnt(4)
  s_barrier
  s_add_u32 m0, s66, 55296
  s_nop 0
  buffer_load_dwordx4 v8, s[68:71], s73 offen lds
  s_add_u32 m0, m0, 1024
  s_nop 0
  buffer_load_dwordx4 v9, s[68:71], s73 offen lds
  s_add_u32 m0, m0, 1024
  s_nop 0
  buffer_load_dwordx4 v10, s[68:71], s73 offen lds
  s_add_u32 m0, s61, 55296
  s_cmp_eq_u32 s76, 0
  buffer_load_dwordx4 v11, s[92:95], s67 offen lds
  s_cbranch_scc1 L_g2f_el1
  buffer_load_dwordx4 v11, s[92:95], s67 offen offset:1024 lds
L_g2f_el1:
  s_add_u32 s73, s73, 114688
  s_cmp_ge_u32 s73, s74
  s_cselect_b32 s39, 1835008, 0
  s_sub_u32 s73, s73, s39
  s_add_u32 s67, s67, s90
  s_cmp_ge_u32 s67, s91
  s_cselect_b32 s39, s60, 0
  s_sub_u32 s67, s67, s39
  s_waitcnt vmcnt(4)
  s_barrier
  s_add_u32 m0, s66, 0
  s_nop 0
  buffer_load_dwordx4 v8, s[68:71], s73 offen lds
  s_add_u32 m0, m0, 1024
  s_nop 0
  buffer_load_dwordx4 v9, s[68:71], s73 offen lds
  s_add_u32 m0, m0, 1024
  s_nop 0
  buffer_load_dwordx4 v10, s[68:71], s73 offen lds
  s_add_u32 m0, s61, 0
  s_cmp_eq_u32 s76, 0
  buffer_load_dwordx4 v11, s[92:95], s67 offen lds
  s_cbranch_scc1 L_g2f_el2
  buffer_load_dwordx4 v11, s[92:95], s67 offen offset:1024 lds
L_g2f_el2:
  s_add_u32 s73, s73, 114688
  s_cmp_ge_u32 s73, s74
  s_cselect_b32 s39, 1835008, 0
  s_sub_u32 s73, s73, s39
  s_add_u32 s67, s67, s90
  s_cmp_ge_u32 s67, s91
  s_cselect_b32 s39, s60, 0
  s_sub_u32 s67, s67, s39
  s_waitcnt vmcnt(4)
  s_barrier
  s_add_u32 m0, s66, 18432
  s_nop 0
  buffer_load_dwordx4 v8, s[68:71], s73 offen lds
  s_add_u32 m0, m0, 1024
  s_nop 0
  buffer_load_dwordx4 v9, s[68:71], s73 offen lds
  s_add_u32 m0, m0, 1024
  s_nop 0
  buffer_load_dwordx4 v10, s[68:71], s73 offen lds
  s_add_u32 m0, s61, 18432
  s_cmp_eq_u32 s76, 0
  buffer_load_dwordx4 v11, s[92:95], s67 offen lds
  s_cbranch_scc1 L_g2f_el3
  buffer_load_dwordx4 v11, s[92:95], s67 offen offset:1024 lds
L_g2f_el3:
  s_add_u32 s73, s73, 114688
  s_cmp_ge_u32 s73, s74
  s_cselect_b32 s39, 1835008, 0
  s_sub_u32 s73, s73, s39
  s_add_u32 s67, s67, s90
  s_cmp_ge_u32 s67, s91
  s_cselect_b32 s39, s60, 0
  s_sub_u32 s67, s67, s39
  s_waitcnt vmcnt(4)
  s_barrier
  s_add_u32 m0, s66, 36864
  s_nop 0
  buffer_load_dwordx4 v8, s[68:71], s73 offen lds
  s_add_u32 m0, m0, 1024
  s_nop 0
  buffer_load_dwordx4 v9, s[68:71], s73 offen lds
  s_add_u32 m0, m0, 1024
  s_nop 0
  buffer_load_dwordx4 v10, s[68:71], s73 offen lds
  s_add_u32 m0, s61, 36864
  s_cmp_eq_u32 s76, 0
  buffer_load_dwordx4 v11, s[92:95], s67 offen lds
  s_cbranch_scc1 L_g2f_el4
  buffer_load_dwordx4 v11, s[92:95], s67 offen offset:1024 lds
L_g2f_el4:
  s_add_u32 s73, s73, 114688
  s_cmp_ge_u32 s73, s74
  s_cselect_b32 s39, 1835008, 0
  s_sub_u32 s73, s73, s39
  s_add_u32 s67, s67, s90
  s_cmp_ge_u32 s67, s91
  s_cselect_b32 s39, s60, 0
  s_sub_u32 s67, s67, s39
  s_waitcnt vmcnt(4)
  s_barrier
  s_add_u32 m0, s66, 55296
  s_nop 0
  buffer_load_dwordx4 v8, s[68:71], s73 offen lds
  s_add_u32 m0, m0, 1024
  s_nop 0
  buffer_load_dwordx4 v9, s[68:71], s73 offen lds
  s_add_u32 m0, m0, 1024
  s_nop 0
  buffer_load_dwordx4 v10, s[68:71], s73 offen lds
  s_add_u32 m0, s61, 55296
  s_cmp_eq_u32 s76, 0
  buffer_load_dwordx4 v11, s[92:95], s67 offen lds
  s_cbranch_scc1 L_g2f_el5
  buffer_load_dwordx4 v11, s[92:95], s67 offen offset:1024 lds
L_g2f_el5:
  s_add_u32 s73, s73, 114688
  s_cmp_ge_u32 s73, s74
  s_cselect_b32 s39, 1835008, 0
  s_sub_u32 s73, s73, s39
  s_add_u32 s67, s67, s90
  s_cmp_ge_u32 s67, s91
  s_cselect_b32 s39, s60, 0
  s_sub_u32 s67, s67, s39
  s_waitcnt vmcnt(4)
  s_barrier
  s_add_u32 m0, s66, 0
  s_nop 0
  buffer_load_dwordx4 v8, s[68:71], s73 offen lds
  s_add_u32 m0, m0, 1024
  s_nop 0
  buffer_load_dwordx4 v9, s[68:71], s73 offen lds
  s_add_u32 m0, m0, 1024
  s_nop 0
  buffer_load_dwordx4 v10, s[68:71], s73 offen lds
  s_add_u32 m0, s61, 0
  s_cmp_eq_u32 s76, 0
  buffer_load_dwordx4 v11, s[92:95], s67 offen lds
  s_cbranch_scc1 L_g2f_el6
  buffer_load_dwordx4 v11, s[92:95], s67 offen offset:1024 lds
L_g2f_el6:
  s_add_u32 s73, s73, 114688
  s_cmp_ge_u32 s73, s74
  s_cselect_b32 s39, 1835008, 0
  s_sub_u32 s73, s73, s39
  s_add_u32 s67, s67, s90
  s_cmp_ge_u32 s67, s91
  s_cselect_b32 s39, s60, 0
  s_sub_u32 s67, s67, s39
  s_waitcnt vmcnt(4)
  s_barrier
  s_add_u32 m0, s66, 18432
  s_nop 0
  buffer_load_dwordx4 v8, s[68:71], s73 offen lds
  s_add_u32 m0, m0, 1024
  s_nop 0
  buffer_load_dwordx4 v9, s[68:71], s73 offen lds
  s_add_u32 m0, m0, 1024
  s_nop 0
  buffer_load_dwordx4 v10, s[68:71], s73 offen lds
  s_add_u32 m0, s61, 18432
  s_cmp_eq_u32 s76, 0
  buffer_load_dwordx4 v11, s[92:95], s67 offen lds
  s_cbranch_scc1 L_g2f_el7
  buffer_load_dwordx4 v11, s[92:95], s67 offen offset:1024 lds
L_g2f_el7:
  s_add_u32 s73, s73, 114688
  s_cmp_ge_u32 s73, s74
  s_cselect_b32 s39, 1835008, 0
  s_sub_u32 s73, s73, s39
  s_add_u32 s67, s67, s90
  s_cmp_ge_u32 s67, s91
  s_cselect_b32 s39, s60, 0
  s_sub_u32 s67, s67, s39
  s_waitcnt vmcnt(4)
  s_barrier
  s_add_u32 m0, s66, 36864
  s_nop 0
  buffer_load_dwordx4 v8, s[68:71], s73 offen lds
  s_add_u32 m0, m0, 1024
  s_nop 0
  buffer_load_dwordx4 v9, s[68:71], s73 offen lds
  s_add_u32 m0, m0, 1024
  s_nop 0
  buffer_load_dwordx4 v10, s[68:71], s73 offen lds
  s_add_u32 m0, s61, 36864
  s_cmp_eq_u32 s76, 0
  buffer_load_dwordx4 v11, s[92:95], s67 offen lds
  s_cbranch_scc1 L_g2f_el8
  buffer_load_dwordx4 v11, s[92:95], s67 offen offset:1024 lds
L_g2f_el8:
  s_add_u32 s73, s73, 114688
  s_cmp_ge_u32 s73, s74
  s_cselect_b32 s39, 1835008, 0
  s_sub_u32 s73, s73, s39
  s_add_u32 s67, s67, s90
  s_cmp_ge_u32 s67, s91
  s_cselect_b32 s39, s60, 0
  s_sub_u32 s67, s67, s39
  s_waitcnt vmcnt(4)
  s_barrier
  s_add_u32 m0, s66, 55296
  s_nop 0
  buffer_load_dwordx4 v8, s[68:71], s73 offen lds
  s_add_u32 m0, m0, 1024
  s_nop 0
  buffer_load_dwordx4 v9, s[68:71], s73 offen lds
  s_add_u32 m0, m0, 1024
  s_nop 0
  buffer_load_dwordx4 v10, s[68:71], s73 offen lds
  s_add_u32 m0, s61, 55296
  s_cmp_eq_u32 s76, 0
  buffer_load_dwordx4 v11, s[92:95], s67 offen lds
  s_cbranch_scc1 L_g2f_el9
  buffer_load_dwordx4 v11, s[92:95], s67 offen offset:1024 lds
L_g2f_el9:
  s_add_u32 s73, s73, 114688
  s_cmp_ge_u32 s73, s74
  s_cselect_b32 s39, 1835008, 0
  s_sub_u32 s73, s73, s39
  s_add_u32 s67, s67, s90
  s_cmp_ge_u32 s67, s91
  s_cselect_b32 s39, s60, 0
  s_sub_u32 s67, s67, s39
  s_waitcnt vmcnt(4)
  s_barrier
  s_add_u32 m0, s66, 0
  s_nop 0
  buffer_load_dwordx4 v8, s[68:71], s73 offen lds
  s_add_u32 m0, m0, 1024
  s_nop 0
  buffer_load_dwordx4 v9, s[68:71], s73 offen lds
  s_add_u32 m0, m0, 1024
  s_nop 0
  buffer_load_dwordx4 v10, s[68:71], s73 offen lds
  s_add_u32 m0, s61, 0
  s_cmp_eq_u32 s76, 0
  buffer_load_dwordx4 v11, s[92:95], s67 offen lds
  s_cbranch_scc1 L_g2f_el10
  buffer_load_dwordx4 v11, s[92:95], s67 offen offset:1024 lds
L_g2f_el10:
  s_add_u32 s73, s73, 114688
  s_cmp_ge_u32 s73, s74
  s_cselect_b32 s39, 1835008, 0
  s_sub_u32 s73, s73, s39
  s_add_u32 s67, s67, s90
  s_cmp_ge_u32 s67, s91
  s_cselect_b32 s39, s60, 0
  s_sub_u32 s67, s67, s39
  s_waitcnt vmcnt(4)
  s_barrier
  s_add_u32 m0, s66, 18432
  s_nop 0
  buffer_load_dwordx4 v8, s[68:71], s73 offen lds
  s_add_u32 m0, m0, 1024
  s_nop 0
  buffer_load_dwordx4 v9, s[68:71], s73 offen lds
  s_add_u32 m0, m0, 1024
  s_nop 0
  buffer_load_dwordx4 v10, s[68:71], s73 offen lds
  s_add_u32 m0, s61, 18432
  s_cmp_eq_u32 s76, 0
  buffer_load_dwordx4 v11, s[92:95], s67 offen lds
  s_cbranch_scc1 L_g2f_el11
  buffer_load_dwordx4 v11, s[92:95], s67 offen offset:1024 lds
L_g2f_el11:
  s_add_u32 s73, s73, 114688
  s_cmp_ge_u32 s73, s74
  s_cselect_b32 s39, 1835008, 0
  s_sub_u32 s73, s73, s39
  s_add_u32 s67, s67, s90
  s_cmp_ge_u32 s67, s91
  s_cselect_b32 s39, s60, 0
  s_sub_u32 s67, s67, s39
  s_waitcnt vmcnt(4)
  s_barrier
  s_add_u32 m0, s66, 36864
  s_nop 0
  buffer_load_dwordx4 v8, s[68:71], s73 offen lds
  s_add_u32 m0, m0, 1024
  s_nop 0
  buffer_load_dwordx4 v9, s[68:71], s73 offen lds
  s_add_u32 m0, m0, 1024
  s_nop 0
  buffer_load_dwordx4 v10, s[68:71], s73 offen lds
  s_add_u32 m0, s61, 36864
  s_cmp_eq_u32 s76, 0
  buffer_load_dwordx4 v11, s[92:95], s67 offen lds
  s_cbranch_scc1 L_g2f_el12
  buffer_load_dwordx4 v11, s[92:95], s67 offen offset:1024 lds
L_g2f_el12:
  s_add_u32 s73, s73, 114688
  s_cmp_ge_u32 s73, s74
  s_cselect_b32 s39, 1835008, 0
  s_sub_u32 s73, s73, s39
  s_add_u32 s67, s67, s90
  s_cmp_ge_u32 s67, s91
  s_cselect_b32 s39, s60, 0
  s_sub_u32 s67, s67, s39
  s_waitcnt vmcnt(4)
  s_barrier
  s_add_u32 m0, s66, 55296
  s_nop 0
  buffer_load_dwordx4 v8, s[68:71], s73 offen lds
  s_add_u32 m0, m0, 1024
  s_nop 0
  buffer_load_dwordx4 v9, s[68:71], s73 offen lds
  s_add_u32 m0, m0, 1024
  s_nop 0
  buffer_load_dwordx4 v10, s[68:71], s73 offen lds
  s_add_u32 m0, s61, 55296
  s_cmp_eq_u32 s76, 0
  buffer_load_dwordx4 v11, s[92:95], s67 offen lds
  s_cbranch_scc1 L_g2f_el13
  buffer_load_dwordx4 v11, s[92:95], s67 offen offset:1024 lds
L_g2f_el13:
  s_add_u32 s73, s73, 114688
  s_cmp_ge_u32 s73, s74
  s_cselect_b32 s39, 1835008, 0
  s_sub_u32 s73, s73, s39
  s_add_u32 s67, s67, s90
  s_cmp_ge_u32 s67, s91
  s_cselect_b32 s39, s60, 0
  s_sub_u32 s67, s67, s39
  s_waitcnt vmcnt(4)
  s_barrier
  s_waitcnt vmcnt(0)
  s_barrier
  s_waitcnt vmcnt(0)
  s_barrier
  s_endpgm
L_g2f_cmp:
  v_bfe_u32 v12, v0, 2, 2
  v_and_b32 v13, 3, v0
  v_bfe_u32 v14, v0, 4, 1
  v_lshl_add_u32 v13, v14, 2, v13
  v_and_b32 v14, 1, v13
  v_lshrrev_b32 v15, 1, v13
  v_lshrrev_b32 v11, 1, v15
  v_and_b32 v15, 1, v15
  v_lshl_add_u32 v15, v14, 1, v15
  v_lshl_add_u32 v13, v11, 2, v15
  v_lshl_add_u32 v14, v2, 3, v12
  v_mul_u32_u24 v14, 448, v14
  v_lshl_add_u32 v14, v13, 3, v14
  s_lshl_b32 s39, s36, 7
  v_add_u32 v8, s39, v14
  v_lshlrev_b32 v3, 4, v0
  v_add_u32 v11, 14336, v3
  s_mov_b32 s75, 0
  s_barrier
  s_lshl_b32 s39, s36, 8
  s_add_u32 s39, s39, 73728
  v_lshl_add_u32 v14, v2, 4, s39
  ds_read_b128 v[64:67], v14 offset:0
  ds_read_b128 v[68:71], v14 offset:32
  ds_read_b128 v[72:75], v14 offset:64
  ds_read_b128 v[76:79], v14 offset:96
  ds_read_b128 v[80:83], v14 offset:128
  ds_read_b128 v[84:87], v14 offset:160
  ds_read_b128 v[88:91], v14 offset:192
  ds_read_b128 v[92:95], v14 offset:224
  ds_read_b128 v[96:99], v14 offset:0
  ds_read_b128 v[100:103], v14 offset:32
  ds_read_b128 v[104:107], v14 offset:64
  ds_read_b128 v[108:111], v14 offset:96
  ds_read_b128 v[112:115], v14 offset:128
  ds_read_b128 v[116:119], v14 offset:160
  ds_read_b128 v[120:123], v14 offset:192
  ds_read_b128 v[124:127], v14 offset:224
  v_add_u32 v9, s75, v8
  v_add_u32 v12, s75, v11
  s_waitcnt lgkmcnt(0)
  s_cmp_eq_u32 s36, 3
  s_cbranch_scc1 L_g2f_one
L_g2f_two:
  ds_read_b128 v[16:19], v12 offset:0
  ds_read_b64_tr_b16 v[32:33], v9 offset:0
  ds_read_b64_tr_b16 v[34:35], v9 offset:1792
  ds_read_b64_tr_b16 v[36:37], v9 offset:64
  ds_read_b64_tr_b16 v[38:39], v9 offset:1856
  ds_read_b128 v[20:23], v12 offset:2048
  s_mov_b32 s77, 0
L_g2f_two_loop:
  s_waitcnt lgkmcnt(3)
  v_mfma_f32_32x32x16_bf16 v[64:79], v[32:35], v[16:19], v[64:79]
  ds_read_b128 v[24:27], v12 offset:1024
  ds_read_b64_tr_b16 v[40:41], v9 offset:7168
  ds_read_b64_tr_b16 v[42:43], v9 offset:8960
  s_add_u32 s75, s75, 18432
  s_cmp_ge_u32 s75, 73728
  s_cselect_b32 s75, 0, s75
  s_waitcnt lgkmcnt(4)
  v_mfma_f32_32x32x16_bf16 v[80:95], v[36:39], v[16:19], v[80:95]
  ds_read_b64_tr_b16 v[44:45], v9 offset:7232
  ds_read_b64_tr_b16 v[46:47], v9 offset:9024
  s_waitcnt lgkmcnt(5)
  v_mfma_f32_32x32x16_bf16 v[96:111], v[32:35], v[20:23], v[96:111]
  ds_read_b128 v[28:31], v12 offset:3072
  s_waitcnt lgkmcnt(6)
  v_mfma_f32_32x32x16_bf16 v[112:127], v[36:39], v[20:23], v[112:127]
  v_add_u32 v10, s75, v8
  v_add_u32 v13, s75, v11
  s_waitcnt lgkmcnt(3)
  v_mfma_f32_32x32x16_bf16 v[64:79], v[40:43], v[24:27], v[64:79]
  s_barrier
  ds_read_b128 v[16:19], v13 offset:0
  ds_read_b64_tr_b16 v[32:33], v10 offset:0
  ds_read_b64_tr_b16 v[34:35], v10 offset:1792
  s_waitcnt lgkmcnt(4)
  v_mfma_f32_32x32x16_bf16 v[80:95], v[44:47], v[24:27], v[80:95]
  ds_read_b64_tr_b16 v[36:37], v10 offset:64
  ds_read_b64_tr_b16 v[38:39], v10 offset:1856
  s_waitcnt lgkmcnt(5)
  v_mfma_f32_32x32x16_bf16 v[96:111], v[40:43], v[28:31], v[96:111]
  ds_read_b128 v[20:23], v13 offset:2048
  s_waitcnt lgkmcnt(6)
  v_mfma_f32_32x32x16_bf16 v[112:127], v[44:47], v[28:31], v[112:127]
  s_waitcnt lgkmcnt(3)
  v_mfma_f32_32x32x16_bf16 v[64:79], v[32:35], v[16:19], v[64:79]
  ds_read_b128 v[24:27], v13 offset:1024
  ds_read_b64_tr_b16 v[40:41], v10 offset:7168
  ds_read_b64_tr_b16 v[42:43], v10 offset:8960
  s_add_u32 s75, s75, 18432
  s_cmp_ge_u32 s75, 73728
  s_cselect_b32 s75, 0, s75
  s_waitcnt lgkmcnt(4)
  v_mfma_f32_32x32x16_bf16 v[80:95], v[36:39], v[16:19], v[80:95]
  ds_read_b64_tr_b16 v[44:45], v10 offset:7232
  ds_read_b64_tr_b16 v[46:47], v10 offset:9024
  s_waitcnt lgkmcnt(5)
  v_mfma_f32_32x32x16_bf16 v[96:111], v[32:35], v[20:23], v[96:111]
  ds_read_b128 v[28:31], v13 offset:3072
  s_waitcnt lgkmcnt(6)
  v_mfma_f32_32x32x16_bf16 v[112:127], v[36:39], v[20:23], v[112:127]
  v_add_u32 v9, s75, v8
  v_add_u32 v12, s75, v11
  s_waitcnt lgkmcnt(3)
  v_mfma_f32_32x32x16_bf16 v[64:79], v[40:43], v[24:27], v[64:79]
  s_barrier
  ds_read_b128 v[16:19], v12 offset:0
  ds_read_b64_tr_b16 v[32:33], v9 offset:0
  ds_read_b64_tr_b16 v[34:35], v9 offset:1792
  s_waitcnt lgkmcnt(4)
  v_mfma_f32_32x32x16_bf16 v[80:95], v[44:47], v[24:27], v[80:95]
  ds_read_b64_tr_b16 v[36:37], v9 offset:64
  ds_read_b64_tr_b16 v[38:39], v9 offset:1856
  s_waitcnt lgkmcnt(5)
  v_mfma_f32_32x32x16_bf16 v[96:111], v[40:43], v[28:31], v[96:111]
  ds_read_b128 v[20:23], v12 offset:2048
  s_waitcnt lgkmcnt(6)
  v_mfma_f32_32x32x16_bf16 v[112:127], v[44:47], v[28:31], v[112:127]
  s_add_u32 s77, s77, 1
  s_cmp_lt_u32 s77, 8
  s_cbranch_scc1 L_g2f_two_loop
  s_branch L_g2f_done
L_g2f_one:
  ds_read_b128 v[16:19], v12 offset:0
  ds_read_b64_tr_b16 v[32:33], v9 offset:0
  ds_read_b64_tr_b16 v[34:35], v9 offset:1792
  ds_read_b128 v[20:23], v12 offset:2048
  s_mov_b32 s77, 0
L_g2f_one_loop:
  s_waitcnt lgkmcnt(1)
  v_mfma_f32_32x32x16_bf16 v[64:79], v[32:35], v[16:19], v[64:79]
  ds_read_b128 v[24:27], v12 offset:1024
  ds_read_b64_tr_b16 v[40:41], v9 offset:7168
  ds_read_b64_tr_b16 v[42:43], v9 offset:8960
  s_add_u32 s75, s75, 18432
  s_cmp_ge_u32 s75, 73728
  s_cselect_b32 s75, 0, s75
  s_waitcnt lgkmcnt(3)
  v_mfma_f32_32x32x16_bf16 v[96:111], v[32:35], v[20:23], v[96:111]
  ds_read_b128 v[28:31], v12 offset:3072
  v_add_u32 v10, s75, v8
  v_add_u32 v13, s75, v11
  s_waitcnt lgkmcnt(1)
  v_mfma_f32_32x32x16_bf16 v[64:79], v[40:43], v[24:27], v[64:79]
  s_barrier
  ds_read_b128 v[16:19], v13 offset:0
  ds_read_b64_tr_b16 v[32:33], v10 offset:0
  ds_read_b64_tr_b16 v[34:35], v10 offset:1792
  s_waitcnt lgkmcnt(3)
  v_mfma_f32_32x32x16_bf16 v[96:111], v[40:43], v[28:31], v[96:111]
  ds_read_b128 v[20:23], v13 offset:2048
  s_waitcnt lgkmcnt(1)
  v_mfma_f32_32x32x16_bf16 v[64:79], v[32:35], v[16:19], v[64:79]
  ds_read_b128 v[24:27], v13 offset:1024
  ds_read_b64_tr_b16 v[40:41], v10 offset:7168
  ds_read_b64_tr_b16 v[42:43], v10 offset:8960
  s_add_u32 s75, s75, 18432
  s_cmp_ge_u32 s75, 73728
  s_cselect_b32 s75, 0, s75
  s_waitcnt lgkmcnt(3)
  v_mfma_f32_32x32x16_bf16 v[96:111], v[32:35], v[20:23], v[96:111]
  ds_read_b128 v[28:31], v13 offset:3072
  v_add_u32 v9, s75, v8
  v_add_u32 v12, s75, v11
  s_waitcnt lgkmcnt(1)
  v_mfma_f32_32x32x16_bf16 v[64:79], v[40:43], v[24:27], v[64:79]
  s_barrier
  ds_read_b128 v[16:19], v12 offset:0
  ds_read_b64_tr_b16 v[32:33], v9 offset:0
  ds_read_b64_tr_b16 v[34:35], v9 offset:1792
  s_waitcnt lgkmcnt(3)
  v_mfma_f32_32x32x16_bf16 v[96:111], v[40:43], v[28:31], v[96:111]
  ds_read_b128 v[20:23], v12 offset:2048
  s_add_u32 s77, s77, 1
  s_cmp_lt_u32 s77, 8
  s_cbranch_scc1 L_g2f_one_loop
L_g2f_done:
  s_waitcnt lgkmcnt(0)
  s_lshl_b32 s40, s37, 1
  s_mul_i32 s39, s40, 147456
  s_mul_i32 s40, s38, 14336
  s_add_u32 s39, s39, s40
  s_lshl_b32 s40, s36, 12
  s_add_u32 s39, s39, s40
  s_add_u32 s39, s39, 0x800000
  v_add_u32 v12, s39, v3
  v_add_u32 v13, 147456, v12
  v_max_f32 v32, 0, v64
  v_max_f32 v33, 0, v65
  v_max_f32 v34, 0, v66
  v_max_f32 v35, 0, v67
  v_max_f32 v36, 0, v68
  v_max_f32 v37, 0, v69
  v_max_f32 v38, 0, v70
  v_max_f32 v39, 0, v71
  v_max_f32 v40, 0, v72
  v_max_f32 v41, 0, v73
  v_max_f32 v42, 0, v74
  v_max_f32 v43, 0, v75
  v_max_f32 v44, 0, v76
  v_max_f32 v45, 0, v77
  v_max_f32 v46, 0, v78
  v_max_f32 v47, 0, v79
  v_pk_mul_f32 v[64:65], v[64:65], v[32:33]
  v_pk_mul_f32 v[66:67], v[66:67], v[34:35]
  v_pk_mul_f32 v[68:69], v[68:69], v[36:37]
  v_pk_mul_f32 v[70:71], v[70:71], v[38:39]
  v_pk_mul_f32 v[72:73], v[72:73], v[40:41]
  v_pk_mul_f32 v[74:75], v[74:75], v[42:43]
  v_pk_mul_f32 v[76:77], v[76:77], v[44:45]
  v_pk_mul_f32 v[78:79], v[78:79], v[46:47]
  v_cvt_pk_bf16_f32 v64, v64, v65
  v_cvt_pk_bf16_f32 v65, v66, v67
  v_cvt_pk_bf16_f32 v66, v68, v69
  v_cvt_pk_bf16_f32 v67, v70, v71
  v_cvt_pk_bf16_f32 v68, v72, v73
  v_cvt_pk_bf16_f32 v69, v74, v75
  v_cvt_pk_bf16_f32 v70, v76, v77
  v_cvt_pk_bf16_f32 v71, v78, v79
  buffer_store_dwordx4 v[64:67], v12, s[16:19], 0 offen offset:0 sc1
  buffer_store_dwordx4 v[68:71], v12, s[16:19], 0 offen offset:1024 sc1
  v_max_f32 v32, 0, v96
  v_max_f32 v33, 0, v97
  v_max_f32 v34, 0, v98
  v_max_f32 v35, 0, v99
  v_max_f32 v36, 0, v100
  v_max_f32 v37, 0, v101
  v_max_f32 v38, 0, v102
  v_max_f32 v39, 0, v103
  v_max_f32 v40, 0, v104
  v_max_f32 v41, 0, v105
  v_max_f32 v42, 0, v106
  v_max_f32 v43, 0, v107
  v_max_f32 v44, 0, v108
  v_max_f32 v45, 0, v109
  v_max_f32 v46, 0, v110
  v_max_f32 v47, 0, v111
  v_pk_mul_f32 v[96:97], v[96:97], v[32:33]
  v_pk_mul_f32 v[98:99], v[98:99], v[34:35]
  v_pk_mul_f32 v[100:101], v[100:101], v[36:37]
  v_pk_mul_f32 v[102:103], v[102:103], v[38:39]
  v_pk_mul_f32 v[104:105], v[104:105], v[40:41]
  v_pk_mul_f32 v[106:107], v[106:107], v[42:43]
  v_pk_mul_f32 v[108:109], v[108:109], v[44:45]
  v_pk_mul_f32 v[110:111], v[110:111], v[46:47]
  v_cvt_pk_bf16_f32 v96, v96, v97
  v_cvt_pk_bf16_f32 v97, v98, v99
  v_cvt_pk_bf16_f32 v98, v100, v101
  v_cvt_pk_bf16_f32 v99, v102, v103
  v_cvt_pk_bf16_f32 v100, v104, v105
  v_cvt_pk_bf16_f32 v101, v106, v107
  v_cvt_pk_bf16_f32 v102, v108, v109
  v_cvt_pk_bf16_f32 v103, v110, v111
  buffer_store_dwordx4 v[96:99], v13, s[16:19], 0 offen offset:0 sc1
  buffer_store_dwordx4 v[100:103], v13, s[16:19], 0 offen offset:1024 sc1
  s_cmp_eq_u32 s36, 3
  s_cbranch_scc1 L_g2f_nost
  v_max_f32 v32, 0, v80
  v_max_f32 v33, 0, v81
  v_max_f32 v34, 0, v82
  v_max_f32 v35, 0, v83
  v_max_f32 v36, 0, v84
  v_max_f32 v37, 0, v85
  v_max_f32 v38, 0, v86
  v_max_f32 v39, 0, v87
  v_max_f32 v40, 0, v88
  v_max_f32 v41, 0, v89
  v_max_f32 v42, 0, v90
  v_max_f32 v43, 0, v91
  v_max_f32 v44, 0, v92
  v_max_f32 v45, 0, v93
  v_max_f32 v46, 0, v94
  v_max_f32 v47, 0, v95
  v_pk_mul_f32 v[80:81], v[80:81], v[32:33]
  v_pk_mul_f32 v[82:83], v[82:83], v[34:35]
  v_pk_mul_f32 v[84:85], v[84:85], v[36:37]
  v_pk_mul_f32 v[86:87], v[86:87], v[38:39]
  v_pk_mul_f32 v[88:89], v[88:89], v[40:41]
  v_pk_mul_f32 v[90:91], v[90:91], v[42:43]
  v_pk_mul_f32 v[92:93], v[92:93], v[44:45]
  v_pk_mul_f32 v[94:95], v[94:95], v[46:47]
  v_cvt_pk_bf16_f32 v80, v80, v81
  v_cvt_pk_bf16_f32 v81, v82, v83
  v_cvt_pk_bf16_f32 v82, v84, v85
  v_cvt_pk_bf16_f32 v83, v86, v87
  v_cvt_pk_bf16_f32 v84, v88, v89
  v_cvt_pk_bf16_f32 v85, v90, v91
  v_cvt_pk_bf16_f32 v86, v92, v93
  v_cvt_pk_bf16_f32 v87, v94, v95
  buffer_store_dwordx4 v[80:83], v12, s[16:19], 0 offen offset:2048 sc1
  buffer_store_dwordx4 v[84:87], v12, s[16:19], 0 offen offset:3072 sc1
  v_max_f32 v32, 0, v112
  v_max_f32 v33, 0, v113
  v_max_f32 v34, 0, v114
  v_max_f32 v35, 0, v115
  v_max_f32 v36, 0, v116
  v_max_f32 v37, 0, v117
  v_max_f32 v38, 0, v118
  v_max_f32 v39, 0, v119
  v_max_f32 v40, 0, v120
  v_max_f32 v41, 0, v121
  v_max_f32 v42, 0, v122
  v_max_f32 v43, 0, v123
  v_max_f32 v44, 0, v124
  v_max_f32 v45, 0, v125
  v_max_f32 v46, 0, v126
  v_max_f32 v47, 0, v127
  v_pk_mul_f32 v[112:113], v[112:113], v[32:33]
  v_pk_mul_f32 v[114:115], v[114:115], v[34:35]
  v_pk_mul_f32 v[116:117], v[116:117], v[36:37]
  v_pk_mul_f32 v[118:119], v[118:119], v[38:39]
  v_pk_mul_f32 v[120:121], v[120:121], v[40:41]
  v_pk_mul_f32 v[122:123], v[122:123], v[42:43]
  v_pk_mul_f32 v[124:125], v[124:125], v[44:45]
  v_pk_mul_f32 v[126:127], v[126:127], v[46:47]
  v_cvt_pk_bf16_f32 v112, v112, v113
  v_cvt_pk_bf16_f32 v113, v114, v115
  v_cvt_pk_bf16_f32 v114, v116, v117
  v_cvt_pk_bf16_f32 v115, v118, v119
  v_cvt_pk_bf16_f32 v116, v120, v121
  v_cvt_pk_bf16_f32 v117, v122, v123
  v_cvt_pk_bf16_f32 v118, v124, v125
  v_cvt_pk_bf16_f32 v119, v126, v127
  buffer_store_dwordx4 v[112:115], v13, s[16:19], 0 offen offset:2048 sc1
  buffer_store_dwordx4 v[116:119], v13, s[16:19], 0 offen offset:3072 sc1
L_g2f_nost:
  s_waitcnt vmcnt(0)
  buffer_load_dwordx4 v[16:19], v12, s[16:19], 0 offen offset:0 sc1
  buffer_load_dwordx4 v[20:23], v12, s[16:19], 0 offen offset:1024 sc1
  buffer_load_dwordx4 v[24:27], v13, s[16:19], 0 offen offset:0 sc1
  buffer_load_dwordx4 v[28:31], v13, s[16:19], 0 offen offset:1024 sc1
  s_cmp_eq_u32 s36, 3
  s_cbranch_scc1 L_g2f_nre
  buffer_load_dwordx4 v[16:19], v12, s[16:19], 0 offen offset:2048 sc1
  buffer_load_dwordx4 v[20:23], v12, s[16:19], 0 offen offset:3072 sc1
  buffer_load_dwordx4 v[24:27], v13, s[16:19], 0 offen offset:2048 sc1
  buffer_load_dwordx4 v[28:31], v13, s[16:19], 0 offen offset:3072 sc1
L_g2f_nre:
L_g2f_post:
  s_barrier
  s_lshl_b32 s77, s37, 7
  s_add_u32 s77, s77, 0x1e02000
  s_cmp_eq_u32 s36, 0
  s_cbranch_scc0 L_g2f_nf
  s_lshl_b32 s39, s38, 2
  s_add_u32 s39, s39, s77
  v_mov_b32 v12, s39
  v_mov_b32 v13, 1
  s_mov_b64 exec, 1
  global_store_dword v12, v13, s[14:15] sc1
  s_mov_b64 exec, -1
L_g2f_nf:
  s_cmp_eq_u32 s36, 0
  s_cbranch_scc0 L_g2f_hw_go
  v_min_u32 v8, 7, v0
  v_lshl_add_u32 v8, v8, 2, s77
  s_mov_b32 s48, 0
L_g2f_hw_poll:
  global_load_dword v9, v8, s[14:15] sc1
  s_add_u32 s48, s48, 1
  s_waitcnt vmcnt(0)
  v_cmp_eq_u32 vcc, 0, v9
  s_nop 1
  s_cmp_eq_u64 vcc, 0
  s_cbranch_scc1 L_g2f_hw_go
  s_sleep 1
  s_cmp_lt_u32 s48, 0x40000
  s_cbranch_scc1 L_g2f_hw_poll
L_g2f_hw_go:
  s_barrier
  s_bfe_u32 s49, s3, 0x30003
  s_bfe_u32 s37, s3, 0x20001
  s_lshl_b32 s37, s37, 3
  s_add_u32 s37, s37, s49
  s_and_b32 s38, s3, 1
  s_lshl_b32 s38, s38, 2
  s_lshr_b32 s39, s3, 6
  s_and_b32 s39, s39, 3
  s_add_u32 s38, s38, s39
  s_mul_i32 s41, s36, 8192
  s_mul_i32 s39, s49, 28
  s_lshr_b32 s39, s39, 3
  s_and_b32 s40, s38, 3
  s_mul_i32 s40, s40, 7
  s_add_u32 s39, s39, s40
  s_cmp_ge_u32 s39, 28
  s_cselect_b32 s40, 28, 0
  s_sub_u32 s39, s39, s40
  s_sub_u32 s45, 28, s39
  s_mul_i32 s40, s36, 28
  s_add_u32 s39, s39, s40
  s_lshl_b32 s44, s39, 14
  s_lshl_b32 s40, s38, 7
  s_add_u32 s44, s44, s40
  s_add_u32 s39, s39, 0
  s_lshl_b32 s39, s39, 10
  s_lshl_b32 s40, s37, 1
  s_mul_i32 s42, s40, 147456
  s_add_u32 s42, s42, s39
  s_add_u32 s42, s42, 0x800000
  s_mov_b32 s47, 28
  v_and_b32 v1, 31, v0
  v_lshrrev_b32 v2, 5, v0
  v_lshlrev_b32 v3, 4, v0
  v_lshrrev_b32 v4, 3, v0
  v_bfe_u32 v5, v0, 2, 1
  v_bfe_u32 v6, v0, 4, 1
  v_xor_b32 v5, v5, v6
  v_and_b32 v6, 3, v0
  v_lshlrev_b32 v6, 4, v6
  v_lshl_add_u32 v5, v5, 6, v6
  v_lshl_add_u32 v4, v4, 10, v5
  v_bfe_u32 v12, v0, 2, 2
  v_and_b32 v13, 3, v0
  v_bfe_u32 v14, v0, 4, 1
  v_lshl_add_u32 v13, v14, 2, v13
  v_and_b32 v14, 1, v13
  v_lshrrev_b32 v15, 1, v13
  v_lshrrev_b32 v8, 1, v15
  v_and_b32 v15, 1, v15
  v_lshl_add_u32 v15, v14, 1, v15
  v_lshl_add_u32 v13, v8, 2, v15
  v_lshl_add_u32 v14, v2, 3, v12
  v_lshlrev_b32 v14, 7, v14
  v_lshl_add_u32 v14, v13, 3, v14
  v_lshrrev_b32 v12, 1, v12
  v_add_u32 v14, s41, v14
  v_xor_b32 v15, 0, v12
  v_lshl_add_u32 v6, v15, 6, v14
  v_xor_b32 v15, 1, v12
  v_lshl_add_u32 v7, v15, 6, v14
  v_mov_b32 v64, 0
  v_mov_b32 v65, 0
  v_mov_b32 v66, 0
  v_mov_b32 v67, 0
  v_mov_b32 v68, 0
  v_mov_b32 v69, 0
  v_mov_b32 v70, 0
  v_mov_b32 v71, 0
  v_mov_b32 v72, 0
  v_mov_b32 v73, 0
  v_mov_b32 v74, 0
  v_mov_b32 v75, 0
  v_mov_b32 v76, 0
  v_mov_b32 v77, 0
  v_mov_b32 v78, 0
  v_mov_b32 v79, 0
  v_mov_b32 v80, 0
  v_mov_b32 v81, 0
  v_mov_b32 v82, 0
  v_mov_b32 v83, 0
  v_mov_b32 v84, 0
  v_mov_b32 v85, 0
  v_mov_b32 v86, 0
  v_mov_b32 v87, 0
  v_mov_b32 v88, 0
  v_mov_b32 v89, 0
  v_mov_b32 v90, 0
  v_mov_b32 v91, 0
  v_mov_b32 v92, 0
  v_mov_b32 v93, 0
  v_mov_b32 v94, 0
  v_mov_b32 v95, 0
  v_mov_b32 v96, 0
  v_mov_b32 v97, 0
  v_mov_b32 v98, 0
  v_mov_b32 v99, 0
  v_mov_b32 v100, 0
  v_mov_b32 v101, 0
  v_mov_b32 v102, 0
  v_mov_b32 v103, 0
  v_mov_b32 v104, 0
  v_mov_b32 v105, 0
  v_mov_b32 v106, 0
  v_mov_b32 v107, 0
  v_mov_b32 v108, 0
  v_mov_b32 v109, 0
  v_mov_b32 v110, 0
  v_mov_b32 v111, 0
  v_mov_b32 v112, 0
  v_mov_b32 v113, 0
  v_mov_b32 v114, 0
  v_mov_b32 v115, 0
  v_mov_b32 v116, 0
  v_mov_b32 v117, 0
  v_mov_b32 v118, 0
  v_mov_b32 v119, 0
  v_mov_b32 v120, 0
  v_mov_b32 v121, 0
  v_mov_b32 v122, 0
  v_mov_b32 v123, 0
  v_mov_b32 v124, 0
  v_mov_b32 v125, 0
  v_mov_b32 v126, 0
  v_mov_b32 v127, 0
  s_waitcnt lgkmcnt(0)
  s_mov_b32 s16, s14
  s_and_b32 s17, s15, 0xffff
  s_mov_b32 s18, 0x1100000
  s_mov_b32 s19, 0x20000
  s_mov_b32 s20, s6
  s_and_b32 s21, s7, 0xffff
  s_mov_b32 s22, 0x1c0000
  s_mov_b32 s23, 0x20000
  s_mov_b32 s28, s4
  s_and_b32 s29, s5, 0xffff
  s_mov_b32 s30, 0x200000
  s_mov_b32 s31, 0x20000
  s_mov_b32 s32, s12
  s_and_b32 s33, s13, 0xffff
  s_mov_b32 s34, 0x200000
  s_mov_b32 s35, 0x20000
  s_mov_b32 s52, s10
  s_and_b32 s53, s11, 0xffff
  s_mov_b32 s54, 0x400
  s_mov_b32 s55, 0x20000
  buffer_load_dwordx4 v[16:19], v3, s[16:19], s42 offen sc1
  s_add_u32 s43, s42, 147456
  buffer_load_dwordx4 v[20:23], v3, s[16:19], s43 offen sc1
  s_add_u32 m0, s41, 0
  s_add_u32 s39, s44, 8192
  buffer_load_dwordx4 v4, s[20:23], s44 offen lds
  s_add_u32 m0, m0, 1024
  s_nop 0
  buffer_load_dwordx4 v4, s[20:23], s39 offen lds
  s_add_u32 s42, s42, 1024
  s_add_u32 s44, s44, 16384
  s_sub_u32 s45, s45, 1
  s_cmp_lg_u32 s45, 0
  s_cbranch_scc1 L_g2a_p0_nw
  s_lshl_b32 s39, s47, 10
  s_sub_u32 s42, s42, s39
  s_lshl_b32 s39, s47, 14
  s_sub_u32 s44, s44, s39
  s_mov_b32 s45, s47
L_g2a_p0_nw:
  buffer_load_dwordx4 v[24:27], v3, s[16:19], s42 offen sc1
  s_add_u32 s43, s42, 147456
  buffer_load_dwordx4 v[28:31], v3, s[16:19], s43 offen sc1
  s_add_u32 m0, s41, 2048
  s_add_u32 s39, s44, 8192
  buffer_load_dwordx4 v4, s[20:23], s44 offen lds
  s_add_u32 m0, m0, 1024
  s_nop 0
  buffer_load_dwordx4 v4, s[20:23], s39 offen lds
  s_add_u32 s42, s42, 1024
  s_add_u32 s44, s44, 16384
  s_sub_u32 s45, s45, 1
  s_cmp_lg_u32 s45, 0
  s_cbranch_scc1 L_g2a_p1_nw
  s_lshl_b32 s39, s47, 10
  s_sub_u32 s42, s42, s39
  s_lshl_b32 s39, s47, 14
  s_sub_u32 s44, s44, s39
  s_mov_b32 s45, s47
L_g2a_p1_nw:
  buffer_load_dwordx4 v[32:35], v3, s[16:19], s42 offen sc1
  s_add_u32 s43, s42, 147456
  buffer_load_dwordx4 v[36:39], v3, s[16:19], s43 offen sc1
  s_add_u32 m0, s41, 4096
  s_add_u32 s39, s44, 8192
  buffer_load_dwordx4 v4, s[20:23], s44 offen lds
  s_add_u32 m0, m0, 1024
  s_nop 0
  buffer_load_dwordx4 v4, s[20:23], s39 offen lds
  s_add_u32 s42, s42, 1024
  s_add_u32 s44, s44, 16384
  s_sub_u32 s45, s45, 1
  s_cmp_lg_u32 s45, 0
  s_cbranch_scc1 L_g2a_p2_nw
  s_lshl_b32 s39, s47, 10
  s_sub_u32 s42, s42, s39
  s_lshl_b32 s39, s47, 14
  s_sub_u32 s44, s44, s39
  s_mov_b32 s45, s47
L_g2a_p2_nw:
  s_setprio 0
  s_waitcnt vmcnt(8)
  ds_read_b64_tr_b16 v[48:49], v6 offset:0
  ds_read_b64_tr_b16 v[50:51], v6 offset:512
  ds_read_b64_tr_b16 v[52:53], v7 offset:0
  ds_read_b64_tr_b16 v[54:55], v7 offset:512
  s_mov_b32 s48, 0
L_g2a_loop:
  s_waitcnt vmcnt(4)
  ds_read_b64_tr_b16 v[56:57], v6 offset:2048
  ds_read_b64_tr_b16 v[58:59], v6 offset:2560
  ds_read_b64_tr_b16 v[60:61], v7 offset:2048
  ds_read_b64_tr_b16 v[62:63], v7 offset:2560
  s_waitcnt lgkmcnt(4)
  v_mfma_f32_32x32x16_bf16 v[64:79], v[48:51], v[16:19], v[64:79]
  buffer_load_dwordx4 v[40:43], v3, s[16:19], s42 offen sc1
  v_mfma_f32_32x32x16_bf16 v[80:95], v[52:55], v[16:19], v[80:95]
  s_add_u32 s43, s42, 147456
  buffer_load_dwordx4 v[44:47], v3, s[16:19], s43 offen sc1
  v_mfma_f32_32x32x16_bf16 v[96:111], v[48:51], v[20:23], v[96:111]
  s_add_u32 m0, s41, 6144
  s_add_u32 s39, s44, 8192
  buffer_load_dwordx4 v4, s[20:23], s44 offen lds
  v_mfma_f32_32x32x16_bf16 v[112:127], v[52:55], v[20:23], v[112:127]
  s_add_u32 m0, m0, 1024
  s_nop 0
  buffer_load_dwordx4 v4, s[20:23], s39 offen lds
  s_add_u32 s42, s42, 1024
  s_add_u32 s44, s44, 16384
  s_sub_u32 s45, s45, 1
  s_cmp_lg_u32 s45, 0
  s_cbranch_scc1 L_g2a_l0_nw
  s_lshl_b32 s39, s47, 10
  s_sub_u32 s42, s42, s39
  s_lshl_b32 s39, s47, 14
  s_sub_u32 s44, s44, s39
  s_mov_b32 s45, s47
L_g2a_l0_nw:
  s_waitcnt vmcnt(4)
  ds_read_b64_tr_b16 v[48:49], v6 offset:4096
  ds_read_b64_tr_b16 v[50:51], v6 offset:4608
  ds_read_b64_tr_b16 v[52:53], v7 offset:4096
  ds_read_b64_tr_b16 v[54:55], v7 offset:4608
  s_waitcnt lgkmcnt(4)
  v_mfma_f32_32x32x16_bf16 v[64:79], v[56:59], v[24:27], v[64:79]
  buffer_load_dwordx4 v[16:19], v3, s[16:19], s42 offen sc1
  v_mfma_f32_32x32x16_bf16 v[80:95], v[60:63], v[24:27], v[80:95]
  s_add_u32 s43, s42, 147456
  buffer_load_dwordx4 v[20:23], v3, s[16:19], s43 offen sc1
  v_mfma_f32_32x32x16_bf16 v[96:111], v[56:59], v[28:31], v[96:111]
  s_add_u32 m0, s41, 0
  s_add_u32 s39, s44, 8192
  buffer_load_dwordx4 v4, s[20:23], s44 offen lds
  v_mfma_f32_32x32x16_bf16 v[112:127], v[60:63], v[28:31], v[112:127]
  s_add_u32 m0, m0, 1024
  s_nop 0
  buffer_load_dwordx4 v4, s[20:23], s39 offen lds
  s_add_u32 s42, s42, 1024
  s_add_u32 s44, s44, 16384
  s_sub_u32 s45, s45, 1
  s_cmp_lg_u32 s45, 0
  s_cbranch_scc1 L_g2a_l1_nw
  s_lshl_b32 s39, s47, 10
  s_sub_u32 s42, s42, s39
  s_lshl_b32 s39, s47, 14
  s_sub_u32 s44, s44, s39
  s_mov_b32 s45, s47
L_g2a_l1_nw:
  s_waitcnt vmcnt(4)
  ds_read_b64_tr_b16 v[56:57], v6 offset:6144
  ds_read_b64_tr_b16 v[58:59], v6 offset:6656
  ds_read_b64_tr_b16 v[60:61], v7 offset:6144
  ds_read_b64_tr_b16 v[62:63], v7 offset:6656
  s_waitcnt lgkmcnt(4)
  v_mfma_f32_32x32x16_bf16 v[64:79], v[48:51], v[32:35], v[64:79]
  buffer_load_dwordx4 v[24:27], v3, s[16:19], s42 offen sc1
  v_mfma_f32_32x32x16_bf16 v[80:95], v[52:55], v[32:35], v[80:95]
  s_add_u32 s43, s42, 147456
  buffer_load_dwordx4 v[28:31], v3, s[16:19], s43 offen sc1
  v_mfma_f32_32x32x16_bf16 v[96:111], v[48:51], v[36:39], v[96:111]
  s_add_u32 m0, s41, 2048
  s_add_u32 s39, s44, 8192
  buffer_load_dwordx4 v4, s[20:23], s44 offen lds
  v_mfma_f32_32x32x16_bf16 v[112:127], v[52:55], v[36:39], v[112:127]
  s_add_u32 m0, m0, 1024
  s_nop 0
  buffer_load_dwordx4 v4, s[20:23], s39 offen lds
  s_add_u32 s42, s42, 1024
  s_add_u32 s44, s44, 16384
  s_sub_u32 s45, s45, 1
  s_cmp_lg_u32 s45, 0
  s_cbranch_scc1 L_g2a_l2_nw
  s_lshl_b32 s39, s47, 10
  s_sub_u32 s42, s42, s39
  s_lshl_b32 s39, s47, 14
  s_sub_u32 s44, s44, s39
  s_mov_b32 s45, s47
L_g2a_l2_nw:
  s_waitcnt vmcnt(4)
  ds_read_b64_tr_b16 v[48:49], v6 offset:0
  ds_read_b64_tr_b16 v[50:51], v6 offset:512
  ds_read_b64_tr_b16 v[52:53], v7 offset:0
  ds_read_b64_tr_b16 v[54:55], v7 offset:512
  s_waitcnt lgkmcnt(4)
  v_mfma_f32_32x32x16_bf16 v[64:79], v[56:59], v[40:43], v[64:79]
  buffer_load_dwordx4 v[32:35], v3, s[16:19], s42 offen sc1
  v_mfma_f32_32x32x16_bf16 v[80:95], v[60:63], v[40:43], v[80:95]
  s_add_u32 s43, s42, 147456
  buffer_load_dwordx4 v[36:39], v3, s[16:19], s43 offen sc1
  v_mfma_f32_32x32x16_bf16 v[96:111], v[56:59], v[44:47], v[96:111]
  s_add_u32 m0, s41, 4096
  s_add_u32 s39, s44, 8192
  buffer_load_dwordx4 v4, s[20:23], s44 offen lds
  v_mfma_f32_32x32x16_bf16 v[112:127], v[60:63], v[44:47], v[112:127]
  s_add_u32 m0, m0, 1024
  s_nop 0
  buffer_load_dwordx4 v4, s[20:23], s39 offen lds
  s_add_u32 s42, s42, 1024
  s_add_u32 s44, s44, 16384
  s_sub_u32 s45, s45, 1
  s_cmp_lg_u32 s45, 0
  s_cbranch_scc1 L_g2a_l3_nw
  s_lshl_b32 s39, s47, 10
  s_sub_u32 s42, s42, s39
  s_lshl_b32 s39, s47, 14
  s_sub_u32 s44, s44, s39
  s_mov_b32 s45, s47
L_g2a_l3_nw:
  s_add_u32 s48, s48, 1
  s_cmp_lt_u32 s48, 6
  s_cbranch_scc1 L_g2a_loop
  s_waitcnt vmcnt(4)
  ds_read_b64_tr_b16 v[56:57], v6 offset:2048
  ds_read_b64_tr_b16 v[58:59], v6 offset:2560
  ds_read_b64_tr_b16 v[60:61], v7 offset:2048
  ds_read_b64_tr_b16 v[62:63], v7 offset:2560
  s_waitcnt lgkmcnt(4)
  v_mfma_f32_32x32x16_bf16 v[64:79], v[48:51], v[16:19], v[64:79]
  buffer_load_dwordx4 v[40:43], v3, s[16:19], s42 offen sc1
  v_mfma_f32_32x32x16_bf16 v[80:95], v[52:55], v[16:19], v[80:95]
  s_add_u32 s43, s42, 147456
  buffer_load_dwordx4 v[44:47], v3, s[16:19], s43 offen sc1
  v_mfma_f32_32x32x16_bf16 v[96:111], v[48:51], v[20:23], v[96:111]
  s_add_u32 m0, s41, 6144
  s_add_u32 s39, s44, 8192
  buffer_load_dwordx4 v4, s[20:23], s44 offen lds
  v_mfma_f32_32x32x16_bf16 v[112:127], v[52:55], v[20:23], v[112:127]
  s_add_u32 m0, m0, 1024
  s_nop 0
  buffer_load_dwordx4 v4, s[20:23], s39 offen lds
  s_add_u32 s42, s42, 1024
  s_add_u32 s44, s44, 16384
  s_sub_u32 s45, s45, 1
  s_cmp_lg_u32 s45, 0
  s_cbranch_scc1 L_g2a_t24_nw
  s_lshl_b32 s39, s47, 10
  s_sub_u32 s42, s42, s39
  s_lshl_b32 s39, s47, 14
  s_sub_u32 s44, s44, s39
  s_mov_b32 s45, s47
L_g2a_t24_nw:
  s_waitcnt vmcnt(4)
  ds_read_b64_tr_b16 v[48:49], v6 offset:4096
  ds_read_b64_tr_b16 v[50:51], v6 offset:4608
  ds_read_b64_tr_b16 v[52:53], v7 offset:4096
  ds_read_b64_tr_b16 v[54:55], v7 offset:4608
  s_waitcnt lgkmcnt(4)
  v_mfma_f32_32x32x16_bf16 v[64:79], v[56:59], v[24:27], v[64:79]
  v_mfma_f32_32x32x16_bf16 v[80:95], v[60:63], v[24:27], v[80:95]
  v_mfma_f32_32x32x16_bf16 v[96:111], v[56:59], v[28:31], v[96:111]
  v_mfma_f32_32x32x16_bf16 v[112:127], v[60:63], v[28:31], v[112:127]
  s_waitcnt vmcnt(0)
  ds_read_b64_tr_b16 v[56:57], v6 offset:6144
  ds_read_b64_tr_b16 v[58:59], v6 offset:6656
  ds_read_b64_tr_b16 v[60:61], v7 offset:6144
  ds_read_b64_tr_b16 v[62:63], v7 offset:6656
  s_waitcnt lgkmcnt(4)
  v_mfma_f32_32x32x16_bf16 v[64:79], v[48:51], v[32:35], v[64:79]
  v_mfma_f32_32x32x16_bf16 v[80:95], v[52:55], v[32:35], v[80:95]
  v_mfma_f32_32x32x16_bf16 v[96:111], v[48:51], v[36:39], v[96:111]
  v_mfma_f32_32x32x16_bf16 v[112:127], v[52:55], v[36:39], v[112:127]
  s_waitcnt lgkmcnt(0)
  v_mfma_f32_32x32x16_bf16 v[64:79], v[56:59], v[40:43], v[64:79]
  v_mfma_f32_32x32x16_bf16 v[80:95], v[60:63], v[40:43], v[80:95]
  v_mfma_f32_32x32x16_bf16 v[96:111], v[56:59], v[44:47], v[96:111]
  v_mfma_f32_32x32x16_bf16 v[112:127], v[60:63], v[44:47], v[112:127]
  s_lshr_b32 s39, s36, 1
  s_lshl_b32 s40, s37, 1
  s_add_u32 s39, s39, s40
  s_lshl_b32 s39, s39, 15
  s_and_b32 s40, s36, 1
  s_lshl_b32 s40, s40, 6
  s_lshl_b32 s47, s38, 7
  s_add_u32 s57, s40, s47
  s_add_u32 s56, s39, s57
  v_lshlrev_b32 v10, 10, v1
  v_lshl_add_u32 v10, v2, 4, v10
  v_lshlrev_b32 v11, 4, v2
  buffer_load_dwordx4 v[32:35], v10, s[28:31], s56 offen
  buffer_load_dwordx4 v[36:39], v10, s[28:31], s56 offen offset:32
  buffer_load_dwordx4 v[40:43], v11, s[52:55], s57 offen
  buffer_load_dwordx4 v[44:47], v11, s[52:55], s57 offen offset:32
  s_nop 15
  s_barrier
  s_cmp_eq_u32 s36, 0
  s_cbranch_scc1 L_g2_nw0
  s_lshl_b32 s39, s36, 14
  v_add_u32 v8, s39, v3
  ds_write_b128 v8, v[64:67] offset:0
  ds_write_b128 v8, v[68:71] offset:1024
  ds_write_b128 v8, v[72:75] offset:2048
  ds_write_b128 v8, v[76:79] offset:3072
L_g2_nw0:
  s_cmp_eq_u32 s36, 1
  s_cbranch_scc1 L_g2_nw1
  s_lshl_b32 s39, s36, 14
  v_add_u32 v8, s39, v3
  ds_write_b128 v8, v[80:83] offset:4096
  ds_write_b128 v8, v[84:87] offset:5120
  ds_write_b128 v8, v[88:91] offset:6144
  ds_write_b128 v8, v[92:95] offset:7168
L_g2_nw1:
  s_cmp_eq_u32 s36, 2
  s_cbranch_scc1 L_g2_nw2
  s_lshl_b32 s39, s36, 14
  v_add_u32 v8, s39, v3
  ds_write_b128 v8, v[96:99] offset:8192
  ds_write_b128 v8, v[100:103] offset:9216
  ds_write_b128 v8, v[104:107] offset:10240
  ds_write_b128 v8, v[108:111] offset:11264
L_g2_nw2:
  s_cmp_eq_u32 s36, 3
  s_cbranch_scc1 L_g2_nw3
  s_lshl_b32 s39, s36, 14
  v_add_u32 v8, s39, v3
  ds_write_b128 v8, v[112:115] offset:12288
  ds_write_b128 v8, v[116:119] offset:13312
  ds_write_b128 v8, v[120:123] offset:14336
  ds_write_b128 v8, v[124:127] offset:15360
L_g2_nw3:
  s_cmp_lg_u32 s36, 0
  s_cbranch_scc1 L_g2_no0
  v_mov_b32 v16, v64
  v_mov_b32 v17, v65
  v_mov_b32 v18, v66
  v_mov_b32 v19, v67
  v_mov_b32 v20, v68
  v_mov_b32 v21, v69
  v_mov_b32 v22, v70
  v_mov_b32 v23, v71
  v_mov_b32 v24, v72
  v_mov_b32 v25, v73
  v_mov_b32 v26, v74
  v_mov_b32 v27, v75
  v_mov_b32 v28, v76
  v_mov_b32 v29, v77
  v_mov_b32 v30, v78
  v_mov_b32 v31, v79
L_g2_no0:
  s_cmp_lg_u32 s36, 1
  s_cbranch_scc1 L_g2_no1
  v_mov_b32 v16, v80
  v_mov_b32 v17, v81
  v_mov_b32 v18, v82
  v_mov_b32 v19, v83
  v_mov_b32 v20, v84
  v_mov_b32 v21, v85
  v_mov_b32 v22, v86
  v_mov_b32 v23, v87
  v_mov_b32 v24, v88
  v_mov_b32 v25, v89
  v_mov_b32 v26, v90
  v_mov_b32 v27, v91
  v_mov_b32 v28, v92
  v_mov_b32 v29, v93
  v_mov_b32 v30, v94
  v_mov_b32 v31, v95
L_g2_no1:
  s_cmp_lg_u32 s36, 2
  s_cbranch_scc1 L_g2_no2
  v_mov_b32 v16, v96
  v_mov_b32 v17, v97
  v_mov_b32 v18, v98
  v_mov_b32 v19, v99
  v_mov_b32 v20, v100
  v_mov_b32 v21, v101
  v_mov_b32 v22, v102
  v_mov_b32 v23, v103
  v_mov_b32 v24, v104
  v_mov_b32 v25, v105
  v_mov_b32 v26, v106
  v_mov_b32 v27, v107
  v_mov_b32 v28, v108
  v_mov_b32 v29, v109
  v_mov_b32 v30, v110
  v_mov_b32 v31, v111
L_g2_no2:
  s_cmp_lg_u32 s36, 3
  s_cbranch_scc1 L_g2_no3
  v_mov_b32 v16, v112
  v_mov_b32 v17, v113
  v_mov_b32 v18, v114
  v_mov_b32 v19, v115
  v_mov_b32 v20, v116
  v_mov_b32 v21, v117
  v_mov_b32 v22, v118
  v_mov_b32 v23, v119
  v_mov_b32 v24, v120
  v_mov_b32 v25, v121
  v_mov_b32 v26, v122
  v_mov_b32 v27, v123
  v_mov_b32 v28, v124
  v_mov_b32 v29, v125
  v_mov_b32 v30, v126
  v_mov_b32 v31, v127
L_g2_no3:
  s_waitcnt lgkmcnt(0)
  s_barrier
  s_lshl_b32 s40, s36, 12
  v_add_u32 v8, s40, v3
  s_add_u32 s40, s36, 1
  s_and_b32 s40, s40, 3
  s_lshl_b32 s40, s40, 14
  v_add_u32 v9, s40, v8
  ds_read_b128 v[64:67], v9 offset:0
  ds_read_b128 v[68:71], v9 offset:1024
  ds_read_b128 v[72:75], v9 offset:2048
  ds_read_b128 v[76:79], v9 offset:3072
  s_add_u32 s40, s36, 2
  s_and_b32 s40, s40, 3
  s_lshl_b32 s40, s40, 14
  v_add_u32 v9, s40, v8
  ds_read_b128 v[80:83], v9 offset:0
  ds_read_b128 v[84:87], v9 offset:1024
  ds_read_b128 v[88:91], v9 offset:2048
  ds_read_b128 v[92:95], v9 offset:3072
  s_add_u32 s40, s36, 3
  s_and_b32 s40, s40, 3
  s_lshl_b32 s40, s40, 14
  v_add_u32 v9, s40, v8
  ds_read_b128 v[96:99], v9 offset:0
  ds_read_b128 v[100:103], v9 offset:1024
  ds_read_b128 v[104:107], v9 offset:2048
  ds_read_b128 v[108:111], v9 offset:3072
  s_waitcnt lgkmcnt(8)
  v_add_f32 v16, v16, v64
  v_add_f32 v17, v17, v65
  v_add_f32 v18, v18, v66
  v_add_f32 v19, v19, v67
  v_add_f32 v20, v20, v68
  v_add_f32 v21, v21, v69
  v_add_f32 v22, v22, v70
  v_add_f32 v23, v23, v71
  v_add_f32 v24, v24, v72
  v_add_f32 v25, v25, v73
  v_add_f32 v26, v26, v74
  v_add_f32 v27, v27, v75
  v_add_f32 v28, v28, v76
  v_add_f32 v29, v29, v77
  v_add_f32 v30, v30, v78
  v_add_f32 v31, v31, v79
  s_waitcnt lgkmcnt(4)
  v_add_f32 v16, v16, v80
  v_add_f32 v17, v17, v81
  v_add_f32 v18, v18, v82
  v_add_f32 v19, v19, v83
  v_add_f32 v20, v20, v84
  v_add_f32 v21, v21, v85
  v_add_f32 v22, v22, v86
  v_add_f32 v23, v23, v87
  v_add_f32 v24, v24, v88
  v_add_f32 v25, v25, v89
  v_add_f32 v26, v26, v90
  v_add_f32 v27, v27, v91
  v_add_f32 v28, v28, v92
  v_add_f32 v29, v29, v93
  v_add_f32 v30, v30, v94
  v_add_f32 v31, v31, v95
  s_waitcnt lgkmcnt(0)
  v_add_f32 v16, v16, v96
  v_add_f32 v17, v17, v97
  v_add_f32 v18, v18, v98
  v_add_f32 v19, v19, v99
  v_add_f32 v20, v20, v100
  v_add_f32 v21, v21, v101
  v_add_f32 v22, v22, v102
  v_add_f32 v23, v23, v103
  v_add_f32 v24, v24, v104
  v_add_f32 v25, v25, v105
  v_add_f32 v26, v26, v106
  v_add_f32 v27, v27, v107
  v_add_f32 v28, v28, v108
  v_add_f32 v29, v29, v109
  v_add_f32 v30, v30, v110
  v_add_f32 v31, v31, v111
  s_waitcnt vmcnt(0)
  v_lshlrev_b32 v12, 16, v32
  v_and_b32 v13, 0xffff0000, v32
  v_add_f32 v16, v16, v12
  v_add_f32 v17, v17, v13
  v_lshlrev_b32 v12, 16, v40
  v_and_b32 v13, 0xffff0000, v40
  v_add_f32 v16, v16, v12
  v_add_f32 v17, v17, v13
  v_lshlrev_b32 v12, 16, v33
  v_and_b32 v13, 0xffff0000, v33
  v_add_f32 v18, v18, v12
  v_add_f32 v19, v19, v13
  v_lshlrev_b32 v12, 16, v41
  v_and_b32 v13, 0xffff0000, v41
  v_add_f32 v18, v18, v12
  v_add_f32 v19, v19, v13
  v_lshlrev_b32 v12, 16, v34
  v_and_b32 v13, 0xffff0000, v34
  v_add_f32 v20, v20, v12
  v_add_f32 v21, v21, v13
  v_lshlrev_b32 v12, 16, v42
  v_and_b32 v13, 0xffff0000, v42
  v_add_f32 v20, v20, v12
  v_add_f32 v21, v21, v13
  v_lshlrev_b32 v12, 16, v35
  v_and_b32 v13, 0xffff0000, v35
  v_add_f32 v22, v22, v12
  v_add_f32 v23, v23, v13
  v_lshlrev_b32 v12, 16, v43
  v_and_b32 v13, 0xffff0000, v43
  v_add_f32 v22, v22, v12
  v_add_f32 v23, v23, v13
  v_lshlrev_b32 v12, 16, v36
  v_and_b32 v13, 0xffff0000, v36
  v_add_f32 v24, v24, v12
  v_add_f32 v25, v25, v13
  v_lshlrev_b32 v12, 16, v44
  v_and_b32 v13, 0xffff0000, v44
  v_add_f32 v24, v24, v12
  v_add_f32 v25, v25, v13
  v_lshlrev_b32 v12, 16, v37
  v_and_b32 v13, 0xffff0000, v37
  v_add_f32 v26, v26, v12
  v_add_f32 v27, v27, v13
  v_lshlrev_b32 v12, 16, v45
  v_and_b32 v13, 0xffff0000, v45
  v_add_f32 v26, v26, v12
  v_add_f32 v27, v27, v13
  v_lshlrev_b32 v12, 16, v38
  v_and_b32 v13, 0xffff0000, v38
  v_add_f32 v28, v28, v12
  v_add_f32 v29, v29, v13
  v_lshlrev_b32 v12, 16, v46
  v_and_b32 v13, 0xffff0000, v46
  v_add_f32 v28, v28, v12
  v_add_f32 v29, v29, v13
  v_lshlrev_b32 v12, 16, v39
  v_and_b32 v13, 0xffff0000, v39
  v_add_f32 v30, v30, v12
  v_add_f32 v31, v31, v13
  v_lshlrev_b32 v12, 16, v47
  v_and_b32 v13, 0xffff0000, v47
  v_add_f32 v30, v30, v12
  v_add_f32 v31, v31, v13
  s_barrier
  s_mov_b32 s20, s8
  s_and_b32 s21, s9, 0xffff
  s_mov_b32 s22, 0x80000
  s_mov_b32 s23, 0x20000
  s_lshl_b32 s39, s36, 17
  s_lshl_b32 s40, s38, 7
  s_add_u32 s39, s39, s40
  s_lshl_b32 m0, s36, 14
  s_mov_b32 s48, 16
L_g2_wst:
  buffer_load_dwordx4 v4, s[20:23], s39 offen lds
  s_add_u32 s39, s39, 8192
  s_add_u32 m0, m0, 1024
  s_sub_u32 s48, s48, 1
  s_cmp_lg_u32 s48, 0
  s_cbranch_scc1 L_g2_wst
  s_and_b32 s47, s36, 1
  s_and_b32 s45, s38, 1
  s_lshl_b32 s45, s45, 3
  v_subrev_u32 v6, s41, v6
  v_subrev_u32 v7, s41, v7
  s_cmp_eq_u32 s47, 0
  s_cselect_b64 vcc, -1, 0
  v_cndmask_b32 v12, v7, v6, vcc
  v_cndmask_b32 v13, v6, v7, vcc
  s_lshl_b32 s39, s47, 15
  s_lshl_b32 s40, s45, 11
  s_add_u32 s46, s39, s40
  v_add_u32 v14, s46, v12
  v_add_u32 v15, s46, v13
  s_sub_u32 s46, s39, s40
  s_add_u32 s46, s46, 16384
  v_add_u32 v6, s46, v12
  v_add_u32 v7, s46, v13
  v_mov_b32 v96, 0
  v_mov_b32 v97, 0
  v_mov_b32 v98, 0
  v_mov_b32 v99, 0
  v_mov_b32 v100, 0
  v_mov_b32 v101, 0
  v_mov_b32 v102, 0
  v_mov_b32 v103, 0
  v_mov_b32 v104, 0
  v_mov_b32 v105, 0
  v_mov_b32 v106, 0
  v_mov_b32 v107, 0
  v_mov_b32 v108, 0
  v_mov_b32 v109, 0
  v_mov_b32 v110, 0
  v_mov_b32 v111, 0
  s_lshr_b32 s39, s36, 1
  s_lshl_b32 s40, s37, 1
  s_add_u32 s39, s39, s40
  s_mul_i32 s42, s39, 147456
  s_lshl_b32 s39, s47, 14
  s_add_u32 s42, s42, s39
  s_add_u32 s42, s42, 0x81c000
  s_lshl_b32 s39, s45, 10
  s_add_u32 s43, s42, s39
  s_sub_u32 s42, s42, s39
  s_lshl_b32 s46, s37, 8
  s_add_u32 s46, s46, 0x1e00000
  s_waitcnt vmcnt(0)
  s_setprio 3
  s_cmp_eq_u32 s36, 0
  s_cbranch_scc0 L_g2_w_go
  v_min_u32 v8, 63, v0
  v_lshl_add_u32 v8, v8, 2, s46
  s_mov_b32 s48, 0
L_g2_w_poll:
  global_load_dword v9, v8, s[14:15] sc1
  s_add_u32 s48, s48, 1
  s_waitcnt vmcnt(0)
  v_cmp_eq_u32 vcc, 0, v9
  s_nop 1
  s_cmp_eq_u64 vcc, 0
  s_cbranch_scc1 L_g2_w_go
  s_cmp_eq_u64 vcc, exec
  s_cbranch_scc0 L_g2_w_near
  s_sleep 12
L_g2_w_near:
  s_sleep 3
  s_cmp_lt_u32 s48, 0x40000
  s_cbranch_scc1 L_g2_w_poll
L_g2_w_go:
  s_barrier
  s_mov_b32 s39, s43
  s_add_u32 s40, s42, 8192
  buffer_load_dwordx4 v[32:35], v3, s[16:19], s39 offen offset:0 sc1
  buffer_load_dwordx4 v[36:39], v3, s[16:19], s39 offen offset:1024 sc1
  buffer_load_dwordx4 v[40:43], v3, s[16:19], s39 offen offset:2048 sc1
  buffer_load_dwordx4 v[44:47], v3, s[16:19], s39 offen offset:3072 sc1
  s_add_u32 s39, s39, 4096
  buffer_load_dwordx4 v[48:51], v3, s[16:19], s39 offen offset:0 sc1
  buffer_load_dwordx4 v[52:55], v3, s[16:19], s39 offen offset:1024 sc1
  buffer_load_dwordx4 v[56:59], v3, s[16:19], s39 offen offset:2048 sc1
  buffer_load_dwordx4 v[60:63], v3, s[16:19], s39 offen offset:3072 sc1
  buffer_load_dwordx4 v[64:67], v3, s[16:19], s40 offen offset:0 sc1
  buffer_load_dwordx4 v[68:71], v3, s[16:19], s40 offen offset:1024 sc1
  buffer_load_dwordx4 v[72:75], v3, s[16:19], s40 offen offset:2048 sc1
  buffer_load_dwordx4 v[76:79], v3, s[16:19], s40 offen offset:3072 sc1
  s_add_u32 s40, s40, 4096
  buffer_load_dwordx4 v[80:83], v3, s[16:19], s40 offen offset:0 sc1
  buffer_load_dwordx4 v[84:87], v3, s[16:19], s40 offen offset:1024 sc1
  buffer_load_dwordx4 v[88:91], v3, s[16:19], s40 offen offset:2048 sc1
  buffer_load_dwordx4 v[92:95], v3, s[16:19], s40 offen offset:3072 sc1
  ds_read_b64_tr_b16 v[112:113], v14 offset:0
  ds_read_b64_tr_b16 v[114:115], v14 offset:512
  ds_read_b64_tr_b16 v[116:117], v15 offset:0
  ds_read_b64_tr_b16 v[118:119], v15 offset:512
  ds_read_b64_tr_b16 v[120:121], v14 offset:2048
  ds_read_b64_tr_b16 v[122:123], v14 offset:2560
  ds_read_b64_tr_b16 v[124:125], v15 offset:2048
  ds_read_b64_tr_b16 v[126:127], v15 offset:2560
  s_waitcnt vmcnt(15) lgkmcnt(4)
  v_mfma_f32_32x32x16_bf16 v[16:31], v[112:115], v[32:35], v[16:31]
  v_mfma_f32_32x32x16_bf16 v[96:111], v[116:119], v[32:35], v[96:111]
  ds_read_b64_tr_b16 v[112:113], v14 offset:4096
  ds_read_b64_tr_b16 v[114:115], v14 offset:4608
  ds_read_b64_tr_b16 v[116:117], v15 offset:4096
  ds_read_b64_tr_b16 v[118:119], v15 offset:4608
  s_waitcnt vmcnt(14) lgkmcnt(4)
  v_mfma_f32_32x32x16_bf16 v[16:31], v[120:123], v[36:39], v[16:31]
  v_mfma_f32_32x32x16_bf16 v[96:111], v[124:127], v[36:39], v[96:111]
  ds_read_b64_tr_b16 v[120:121], v14 offset:6144
  ds_read_b64_tr_b16 v[122:123], v14 offset:6656
  ds_read_b64_tr_b16 v[124:125], v15 offset:6144
  ds_read_b64_tr_b16 v[126:127], v15 offset:6656
  s_waitcnt vmcnt(13) lgkmcnt(4)
  v_mfma_f32_32x32x16_bf16 v[16:31], v[112:115], v[40:43], v[16:31]
  v_mfma_f32_32x32x16_bf16 v[96:111], v[116:119], v[40:43], v[96:111]
  ds_read_b64_tr_b16 v[112:113], v14 offset:8192
  ds_read_b64_tr_b16 v[114:115], v14 offset:8704
  ds_read_b64_tr_b16 v[116:117], v15 offset:8192
  ds_read_b64_tr_b16 v[118:119], v15 offset:8704
  s_waitcnt vmcnt(12) lgkmcnt(4)
  v_mfma_f32_32x32x16_bf16 v[16:31], v[120:123], v[44:47], v[16:31]
  v_mfma_f32_32x32x16_bf16 v[96:111], v[124:127], v[44:47], v[96:111]
  ds_read_b64_tr_b16 v[120:121], v14 offset:10240
  ds_read_b64_tr_b16 v[122:123], v14 offset:10752
  ds_read_b64_tr_b16 v[124:125], v15 offset:10240
  ds_read_b64_tr_b16 v[126:127], v15 offset:10752
  s_waitcnt vmcnt(11) lgkmcnt(4)
  v_mfma_f32_32x32x16_bf16 v[16:31], v[112:115], v[48:51], v[16:31]
  v_mfma_f32_32x32x16_bf16 v[96:111], v[116:119], v[48:51], v[96:111]
  ds_read_b64_tr_b16 v[112:113], v14 offset:12288
  ds_read_b64_tr_b16 v[114:115], v14 offset:12800
  ds_read_b64_tr_b16 v[116:117], v15 offset:12288
  ds_read_b64_tr_b16 v[118:119], v15 offset:12800
  s_waitcnt vmcnt(10) lgkmcnt(4)
  v_mfma_f32_32x32x16_bf16 v[16:31], v[120:123], v[52:55], v[16:31]
  v_mfma_f32_32x32x16_bf16 v[96:111], v[124:127], v[52:55], v[96:111]
  ds_read_b64_tr_b16 v[120:121], v14 offset:14336
  ds_read_b64_tr_b16 v[122:123], v14 offset:14848
  ds_read_b64_tr_b16 v[124:125], v15 offset:14336
  ds_read_b64_tr_b16 v[126:127], v15 offset:14848
  s_waitcnt vmcnt(9) lgkmcnt(4)
  v_mfma_f32_32x32x16_bf16 v[16:31], v[112:115], v[56:59], v[16:31]
  v_mfma_f32_32x32x16_bf16 v[96:111], v[116:119], v[56:59], v[96:111]
  ds_read_b64_tr_b16 v[112:113], v6 offset:0
  ds_read_b64_tr_b16 v[114:115], v6 offset:512
  ds_read_b64_tr_b16 v[116:117], v7 offset:0
  ds_read_b64_tr_b16 v[118:119], v7 offset:512
  s_waitcnt vmcnt(8) lgkmcnt(4)
  v_mfma_f32_32x32x16_bf16 v[16:31], v[120:123], v[60:63], v[16:31]
  v_mfma_f32_32x32x16_bf16 v[96:111], v[124:127], v[60:63], v[96:111]
  ds_read_b64_tr_b16 v[120:121], v6 offset:2048
  ds_read_b64_tr_b16 v[122:123], v6 offset:2560
  ds_read_b64_tr_b16 v[124:125], v7 offset:2048
  ds_read_b64_tr_b16 v[126:127], v7 offset:2560
  s_waitcnt vmcnt(7) lgkmcnt(4)
  v_mfma_f32_32x32x16_bf16 v[16:31], v[112:115], v[64:67], v[16:31]
  v_mfma_f32_32x32x16_bf16 v[96:111], v[116:119], v[64:67], v[96:111]
  ds_read_b64_tr_b16 v[112:113], v6 offset:4096
  ds_read_b64_tr_b16 v[114:115], v6 offset:4608
  ds_read_b64_tr_b16 v[116:117], v7 offset:4096
  ds_read_b64_tr_b16 v[118:119], v7 offset:4608
  s_waitcnt vmcnt(6) lgkmcnt(4)
  v_mfma_f32_32x32x16_bf16 v[16:31], v[120:123], v[68:71], v[16:31]
  v_mfma_f32_32x32x16_bf16 v[96:111], v[124:127], v[68:71], v[96:111]
  ds_read_b64_tr_b16 v[120:121], v6 offset:6144
  ds_read_b64_tr_b16 v[122:123], v6 offset:6656
  ds_read_b64_tr_b16 v[124:125], v7 offset:6144
  ds_read_b64_tr_b16 v[126:127], v7 offset:6656
  s_waitcnt vmcnt(5) lgkmcnt(4)
  v_mfma_f32_32x32x16_bf16 v[16:31], v[112:115], v[72:75], v[16:31]
  v_mfma_f32_32x32x16_bf16 v[96:111], v[116:119], v[72:75], v[96:111]
  ds_read_b64_tr_b16 v[112:113], v6 offset:8192
  ds_read_b64_tr_b16 v[114:115], v6 offset:8704
  ds_read_b64_tr_b16 v[116:117], v7 offset:8192
  ds_read_b64_tr_b16 v[118:119], v7 offset:8704
  s_waitcnt vmcnt(4) lgkmcnt(4)
  v_mfma_f32_32x32x16_bf16 v[16:31], v[120:123], v[76:79], v[16:31]
  v_mfma_f32_32x32x16_bf16 v[96:111], v[124:127], v[76:79], v[96:111]
  ds_read_b64_tr_b16 v[120:121], v6 offset:10240
  ds_read_b64_tr_b16 v[122:123], v6 offset:10752
  ds_read_b64_tr_b16 v[124:125], v7 offset:10240
  ds_read_b64_tr_b16 v[126:127], v7 offset:10752
  s_waitcnt vmcnt(3) lgkmcnt(4)
  v_mfma_f32_32x32x16_bf16 v[16:31], v[112:115], v[80:83], v[16:31]
  v_mfma_f32_32x32x16_bf16 v[96:111], v[116:119], v[80:83], v[96:111]
  ds_read_b64_tr_b16 v[112:113], v6 offset:12288
  ds_read_b64_tr_b16 v[114:115], v6 offset:12800
  ds_read_b64_tr_b16 v[116:117], v7 offset:12288
  ds_read_b64_tr_b16 v[118:119], v7 offset:12800
  s_waitcnt vmcnt(2) lgkmcnt(4)
  v_mfma_f32_32x32x16_bf16 v[16:31], v[120:123], v[84:87], v[16:31]
  v_mfma_f32_32x32x16_bf16 v[96:111], v[124:127], v[84:87], v[96:111]
  ds_read_b64_tr_b16 v[120:121], v6 offset:14336
  ds_read_b64_tr_b16 v[122:123], v6 offset:14848
  ds_read_b64_tr_b16 v[124:125], v7 offset:14336
  ds_read_b64_tr_b16 v[126:127], v7 offset:14848
  s_waitcnt vmcnt(1) lgkmcnt(4)
  v_mfma_f32_32x32x16_bf16 v[16:31], v[112:115], v[88:91], v[16:31]
  v_mfma_f32_32x32x16_bf16 v[96:111], v[116:119], v[88:91], v[96:111]
  s_waitcnt vmcnt(0) lgkmcnt(0)
  v_mfma_f32_32x32x16_bf16 v[16:31], v[120:123], v[92:95], v[16:31]
  v_mfma_f32_32x32x16_bf16 v[96:111], v[124:127], v[92:95], v[96:111]
  s_barrier
  s_xor_b32 s39, s36, 1
  s_lshl_b32 s39, s39, 12
  v_add_u32 v12, s39, v3
  s_lshl_b32 s39, s36, 12
  v_add_u32 v13, s39, v3
  s_nop 7
  ds_write_b128 v12, v[96:99] offset:0
  ds_write_b128 v12, v[100:103] offset:1024
  ds_write_b128 v12, v[104:107] offset:2048
  ds_write_b128 v12, v[108:111] offset:3072
  s_waitcnt lgkmcnt(0)
  s_barrier
  ds_read_b128 v[32:35], v13 offset:0
  ds_read_b128 v[36:39], v13 offset:1024
  ds_read_b128 v[40:43], v13 offset:2048
  ds_read_b128 v[44:47], v13 offset:3072
  v_lshlrev_b32 v10, 10, v1
  v_lshl_add_u32 v10, v2, 4, v10
  s_waitcnt lgkmcnt(3)
  v_add_f32 v16, v16, v32
  v_add_f32 v17, v17, v33
  v_add_f32 v18, v18, v34
  v_add_f32 v19, v19, v35
  s_waitcnt lgkmcnt(2)
  v_add_f32 v20, v20, v36
  v_add_f32 v21, v21, v37
  v_add_f32 v22, v22, v38
  v_add_f32 v23, v23, v39
  s_waitcnt lgkmcnt(1)
  v_add_f32 v24, v24, v40
  v_add_f32 v25, v25, v41
  v_add_f32 v26, v26, v42
  v_add_f32 v27, v27, v43
  s_waitcnt lgkmcnt(0)
  v_add_f32 v28, v28, v44
  v_add_f32 v29, v29, v45
  v_add_f32 v30, v30, v46
  v_add_f32 v31, v31, v47
  v_cvt_pk_bf16_f32 v16, v16, v17
  v_cvt_pk_bf16_f32 v17, v18, v19
  v_cvt_pk_bf16_f32 v18, v20, v21
  v_cvt_pk_bf16_f32 v19, v22, v23
  v_cvt_pk_bf16_f32 v20, v24, v25
  v_cvt_pk_bf16_f32 v21, v26, v27
  v_cvt_pk_bf16_f32 v22, v28, v29
  v_cvt_pk_bf16_f32 v23, v30, v31
  buffer_store_dwordx4 v[16:19], v10, s[32:35], s56 offen
  buffer_store_dwordx4 v[20:23], v10, s[32:35], s56 offen offset:32
L_g2_exit:
  s_endpgm
L_attn_exit:
  s_endpgm
.section .rodata,"a"
.p2align 6
.amdhsa_kernel k2_kernel
  .amdhsa_next_free_vgpr 128
  .amdhsa_next_free_sgpr 96
  .amdhsa_accum_offset 128
  .amdhsa_group_segment_fixed_size 0
  .amdhsa_kernarg_size 88
  .amdhsa_user_sgpr_count 2
  .amdhsa_user_sgpr_kernarg_segment_ptr 1
  .amdhsa_system_sgpr_workgroup_id_x 1
  .amdhsa_float_denorm_mode_32 3
.end_amdhsa_kernel
.text
L_text_end:
```
